```python
import torch

def _softmax(x, axis=-1):
    return torch.softmax(x, dim=axis)
def _gelu(x):
    return torch.nn.functional.gelu(x, approximate="tanh")
def _silu(x):
    return torch.nn.functional.silu(x)
def _sigmoid(x):
    return torch.sigmoid(x)
def _layernorm(x, axis=-1, eps=1e-5):
    m = x.mean(dim=axis, keepdim=True)
    v = x.var(dim=axis, keepdim=True, unbiased=False)
    return (x - m) / torch.sqrt(v + eps)
def _scatter_add(tgt, idx, src, axis=0):
    return tgt.clone().index_add_(axis, idx, src)
def _segment_sum(src, seg, n):
    out = torch.zeros((n,) + src.shape[1:], dtype=src.dtype)
    return out.index_add_(0, seg, src)
def _pad(x, pw):
    flat = tuple(v for pair in reversed(pw) for v in pair)
    return torch.nn.functional.pad(x, flat)

kernel_name = 'standalone__spectral_conv_chebnet__graph'

def setup_inputs():

    _w = (lambda a: (lambda t: t.to(torch.bfloat16) if t.is_floating_point() else t)(torch.as_tensor(a)))
    N, deg, D, K = 50000, 16, 64, 2
    E = N * deg
    src = (lambda lo, hi, *s: torch.randint(lo, hi, s))(0, N, E).to(torch.int64)
    dst = (lambda lo, hi, *s: torch.randint(lo, hi, s))(0, N, E).to(torch.int64)
    deg_cnt = torch.bincount(dst, minlength=N).to(float) + 1.0
    dis = (1.0 / (lambda _x: torch.sqrt(torch.as_tensor(_x)))(deg_cnt)).to(float)
    ew = -(dis[src] * dis[dst])
    return {
        "x": _w((lambda *s: torch.randn(*s, dtype=torch.bfloat16) * 0.05)(N, D)),
        "src": _w(src),
        "dst": _w(dst),
        "ew": _w(ew),
        "w": _w((lambda *s: torch.randn(*s, dtype=torch.bfloat16) * 0.05)(K, D, D) * 0.2),
    }

def reference(x, src, dst, ew, w):
    N, K = x.shape[0], w.shape[0]
    Ts = [x]
    if K > 1:
        Ts.append(_segment_sum(ew[:, None] * x[src], dst, N))
    for k in range(2, K):
        Tk = 2.0 * _segment_sum(ew[:, None] * Ts[-1][src], dst, N) - Ts[-2]
        Ts.append(Tk)
    T = torch.stack(Ts, 0)
    return torch.einsum('knd,kde->ne', T, w)
```

```asm
; @launch kernel=cheb_a_kernel grid=(256,1,1) block=(1024,1,1) lds=27072
; @launch kernel=cheb_b_kernel grid=(256,1,1) block=(1024,1,1) lds=136192
.amdgcn_target "amdgcn-amd-amdhsa--gfx950"
.text
.globl cheb_a_kernel
.p2align 8
.type cheb_a_kernel,@function
cheb_a_kernel:
s_cmp_ge_u32 s2, 256
s_cbranch_scc1 LA_end
s_load_dwordx4 s[4:7], s[0:1], 8
s_load_dwordx2 s[24:25], s[0:1], 24
s_load_dwordx2 s[26:27], s[0:1], 56
s_waitcnt lgkmcnt(0)
s_mov_b32 s8, s4
s_and_b32 s9, s5, 0xffff
s_mov_b32 s10, 3200000
s_mov_b32 s11, 0x00020000
s_mov_b32 s12, s6
s_and_b32 s13, s7, 0xffff
s_mov_b32 s14, 3200000
s_mov_b32 s15, 0x00020000
s_mov_b32 s16, s24
s_and_b32 s17, s25, 0xffff
s_mov_b32 s18, 1600000
s_mov_b32 s19, 0x00020000
s_mov_b32 s20, s26
s_and_b32 s21, s27, 0xffff
s_mov_b32 s22, 6684672
s_mov_b32 s23, 0x00020000
s_cmp_lg_u32 s2, 0
s_cbranch_scc1 LA_now
s_load_dwordx2 s[52:53], s[0:1], 32
s_waitcnt lgkmcnt(0)
s_mov_b32 s48, s52
s_and_b32 s49, s53, 0xffff
s_mov_b32 s50, 16384
s_mov_b32 s51, 0x00020000
v_and_b32 v72, 63, v0
v_lshrrev_b32 v73, 6, v0
v_lshlrev_b32 v3, 10, v73
v_lshl_add_u32 v3, v72, 1, v3
buffer_load_ushort v64, v3, s[48:51], 0 offen offset:0
buffer_load_ushort v65, v3, s[48:51], 0 offen offset:128
buffer_load_ushort v66, v3, s[48:51], 0 offen offset:256
buffer_load_ushort v67, v3, s[48:51], 0 offen offset:384
buffer_load_ushort v68, v3, s[48:51], 0 offen offset:512
buffer_load_ushort v69, v3, s[48:51], 0 offen offset:640
buffer_load_ushort v70, v3, s[48:51], 0 offen offset:768
buffer_load_ushort v71, v3, s[48:51], 0 offen offset:896
LA_now:
s_mul_i32 s3, s2, 3128
s_sub_u32 s43, 800000, s3
s_min_u32 s43, s43, 3128
s_lshr_b32 s43, s43, 2
v_cmp_gt_u32 s[30:31], s43, v0
s_mov_b64 exec, s[30:31]
v_lshlrev_b32 v5, 4, v0
v_lshlrev_b32 v6, 3, v0
s_lshl_b32 s44, s3, 2
s_lshl_b32 s45, s3, 1
buffer_load_dwordx4 v[10:13], v5, s[12:15], s44 offen
buffer_load_dwordx4 v[14:17], v5, s[8:11], s44 offen
buffer_load_dwordx2 v[18:19], v6, s[16:19], s45 offen
s_mov_b64 exec, -1
v_lshlrev_b32 v1, 2, v0
v_mov_b32 v2, 0
v_cmp_gt_u32 vcc, 256, v0
s_and_saveexec_b64 s[28:29], vcc
ds_write_b32 v1, v2
s_mov_b64 exec, s[28:29]
s_waitcnt lgkmcnt(0)
s_barrier
v_mov_b32 v7, 1
s_mov_b32 s40, 21913099
s_mov_b64 exec, s[30:31]
s_waitcnt vmcnt(2)
v_mul_hi_u32 v22, s40, v10
v_lshlrev_b32 v22, 2, v22
ds_add_rtn_u32 v26, v22, v7
v_mul_hi_u32 v23, s40, v11
v_lshlrev_b32 v23, 2, v23
ds_add_rtn_u32 v27, v23, v7
v_mul_hi_u32 v24, s40, v12
v_lshlrev_b32 v24, 2, v24
ds_add_rtn_u32 v28, v24, v7
v_mul_hi_u32 v25, s40, v13
v_lshlrev_b32 v25, 2, v25
ds_add_rtn_u32 v29, v25, v7
s_waitcnt vmcnt(0)
v_and_b32 v30, 0xffff, v18
v_lshrrev_b32 v31, 16, v18
v_and_b32 v32, 0xffff, v19
v_lshrrev_b32 v33, 16, v19
v_mul_u32_u24 v9, 49, v22
v_sub_u32 v9, v10, v9
v_lshl_or_b32 v30, v9, 16, v30
v_mul_u32_u24 v9, 49, v23
v_sub_u32 v9, v11, v9
v_lshl_or_b32 v31, v9, 16, v31
v_mul_u32_u24 v9, 49, v24
v_sub_u32 v9, v12, v9
v_lshl_or_b32 v32, v9, 16, v32
v_mul_u32_u24 v9, 49, v25
v_sub_u32 v9, v13, v9
v_lshl_or_b32 v33, v9, 16, v33
s_mov_b64 exec, -1
s_waitcnt lgkmcnt(0)
s_barrier
v_and_b32 v2, 63, v0
v_lshlrev_b32 v1, 4, v2
ds_read_b128 v[34:37], v1
s_waitcnt lgkmcnt(0)
v_add_u32 v38, v34, v35
v_add_u32 v39, v38, v36
v_add_u32 v40, v39, v37
s_nop 1
v_add_u32_dpp v40, v40, v40 row_shr:1 row_mask:0xf bank_mask:0xf bound_ctrl:0
s_nop 1
v_add_u32_dpp v40, v40, v40 row_shr:2 row_mask:0xf bank_mask:0xf bound_ctrl:0
s_nop 1
v_add_u32_dpp v40, v40, v40 row_shr:4 row_mask:0xf bank_mask:0xf bound_ctrl:0
s_nop 1
v_add_u32_dpp v40, v40, v40 row_shr:8 row_mask:0xf bank_mask:0xf bound_ctrl:0
s_nop 1
v_add_u32_dpp v40, v40, v40 row_bcast:15 row_mask:0xa bank_mask:0xf
s_nop 1
v_add_u32_dpp v40, v40, v40 row_bcast:31 row_mask:0xc bank_mask:0xf
s_nop 1
v_sub_u32 v42, v40, v39
v_sub_u32 v42, v42, v37
v_add_u32 v43, v42, v34
v_add_u32 v44, v42, v38
v_add_u32 v45, v42, v39
ds_write_b128 v1, v[42:45] offset:1024
v_cmp_gt_u32 vcc, 64, v0
s_and_saveexec_b64 s[28:29], vcc
s_cbranch_execz LA_skip
s_lshl_b32 s41, s2, 2
s_add_u32 s41, s41, 6406144
v_lshlrev_b32 v3, 12, v0
v_lshl_or_b32 v46, v34, 16, v42
buffer_store_dword v46, v3, s[20:23], s41 offen offset:0
v_lshl_or_b32 v47, v35, 16, v43
buffer_store_dword v47, v3, s[20:23], s41 offen offset:1024
v_lshl_or_b32 v48, v36, 16, v44
buffer_store_dword v48, v3, s[20:23], s41 offen offset:2048
v_lshl_or_b32 v49, v37, 16, v45
buffer_store_dword v49, v3, s[20:23], s41 offen offset:3072
LA_skip:
s_mov_b64 exec, s[30:31]
ds_read_b32 v50, v22 offset:1024
ds_read_b32 v51, v23 offset:1024
ds_read_b32 v52, v24 offset:1024
ds_read_b32 v53, v25 offset:1024
s_waitcnt lgkmcnt(0)
v_add_u32 v9, v50, v26
v_lshlrev_b32 v9, 3, v9
v_mov_b32 v54, v14
v_mov_b32 v55, v30
ds_write_b64 v9, v[54:55] offset:2048
v_add_u32 v9, v51, v27
v_lshlrev_b32 v9, 3, v9
v_mov_b32 v54, v15
v_mov_b32 v55, v31
ds_write_b64 v9, v[54:55] offset:2048
v_add_u32 v9, v52, v28
v_lshlrev_b32 v9, 3, v9
v_mov_b32 v54, v16
v_mov_b32 v55, v32
ds_write_b64 v9, v[54:55] offset:2048
v_add_u32 v9, v53, v29
v_lshlrev_b32 v9, 3, v9
v_mov_b32 v54, v17
v_mov_b32 v55, v33
ds_write_b64 v9, v[54:55] offset:2048
s_mov_b64 exec, -1
s_waitcnt lgkmcnt(0)
s_barrier
s_mul_i32 s42, s2, 25024
s_lshl_b32 s46, s43, 1
v_lshlrev_b32 v3, 4, v0
v_cmp_gt_u32 vcc, s46, v0
s_and_saveexec_b64 s[28:29], vcc
ds_read_b128 v[56:59], v3 offset:2048
s_mov_b64 exec, s[28:29]
v_add_u32 v4, 1024, v0
v_cmp_gt_u32 s[32:33], s46, v4
s_mov_b64 exec, s[32:33]
ds_read_b128 v[60:63], v3 offset:18432
s_mov_b64 exec, -1
s_waitcnt lgkmcnt(0)
s_mov_b64 exec, vcc
buffer_store_dwordx4 v[56:59], v3, s[20:23], s42 offen
s_mov_b64 exec, s[32:33]
s_add_u32 s42, s42, 16384
buffer_store_dwordx4 v[60:63], v3, s[20:23], s42 offen
s_mov_b64 exec, -1
s_cmp_lg_u32 s2, 0
s_cbranch_scc1 LA_end
v_lshl_or_b32 v16, v65, 16, v64
v_lshl_or_b32 v17, v67, 16, v66
v_lshl_or_b32 v18, v69, 16, v68
v_lshl_or_b32 v19, v71, 16, v70
v_lshlrev_b32 v4, 8, v72
v_lshl_add_u32 v4, v73, 4, v4
s_mov_b32 s46, 6668288
buffer_store_dwordx4 v[16:19], v4, s[20:23], s46 offen
LA_end:
s_endpgm
.globl cheb_b_kernel
.p2align 8
.type cheb_b_kernel,@function
cheb_b_kernel:
s_cmp_ge_u32 s2, 256
s_cbranch_scc1 LB_end
s_load_dwordx2 s[4:5], s[0:1], 0
s_load_dwordx4 s[24:27], s[0:1], 32
s_load_dwordx2 s[6:7], s[0:1], 56
s_waitcnt lgkmcnt(0)
s_mov_b32 s8, s4
s_and_b32 s9, s5, 0xffff
s_mov_b32 s10, 6400000
s_mov_b32 s11, 0x00020000
s_mov_b32 s12, s24
s_and_b32 s13, s25, 0xffff
s_mov_b32 s14, 16384
s_mov_b32 s15, 0x00020000
s_mov_b32 s16, s26
s_and_b32 s17, s27, 0xffff
s_mov_b32 s18, 6400000
s_mov_b32 s19, 0x00020000
s_mov_b32 s20, s6
s_and_b32 s21, s7, 0xffff
s_mov_b32 s22, 6684672
s_mov_b32 s23, 0x00020000
v_lshrrev_b32 v1, 6, v0
s_nop 0
v_readfirstlane_b32 s3, v1
v_and_b32 v2, 63, v0
s_lshl_b32 s28, s2, 10
s_add_u32 s28, s28, 6406144
v_lshlrev_b32 v3, 4, v2
buffer_load_dwordx4 v[4:7], v3, s[20:23], s28 offen
v_lshrrev_b32 v9, 5, v2
v_lshlrev_b32 v8, 2, v9
s_lshl_b32 s29, s3, 6
v_add_u32 v8, s29, v8
buffer_load_dword v40, v8, s[20:23], s28 offen offset:0
buffer_load_dword v41, v8, s[20:23], s28 offen offset:8
buffer_load_dword v42, v8, s[20:23], s28 offen offset:16
buffer_load_dword v43, v8, s[20:23], s28 offen offset:24
buffer_load_dword v44, v8, s[20:23], s28 offen offset:32
buffer_load_dword v45, v8, s[20:23], s28 offen offset:40
buffer_load_dword v46, v8, s[20:23], s28 offen offset:48
buffer_load_dword v47, v8, s[20:23], s28 offen offset:56
v_mov_b32 v12, 0
v_mov_b32 v13, 0
v_mov_b32 v14, 0
v_mov_b32 v15, 0
v_lshlrev_b32 v3, 4, v0
v_add_u32 v1, 2112, v3
ds_write_b128 v1, v[12:15]
v_add_u32 v1, 18496, v3
ds_write_b128 v1, v[12:15]
v_add_u32 v1, 34880, v3
ds_write_b128 v1, v[12:15]
v_add_u32 v1, 51264, v3
ds_write_b128 v1, v[12:15]
v_add_u32 v1, 67648, v3
ds_write_b128 v1, v[12:15]
v_add_u32 v1, 81920, v3
v_cmp_gt_u32 vcc, 97824, v1
s_and_saveexec_b64 s[30:31], vcc
v_add_u32 v1, 2112, v1
ds_write_b128 v1, v[12:15]
s_mov_b64 exec, s[30:31]
v_cmp_gt_u32 vcc, 64, v0
s_and_saveexec_b64 s[30:31], vcc
ds_write_b128 v3, v[12:15]
s_mov_b64 exec, s[30:31]
s_waitcnt lgkmcnt(0)
s_barrier
v_mov_b32 v13, 0x00ff0000
v_mov_b32 v15, 0x00ff0000
v_cmp_gt_u32 vcc, 2, v2
s_and_saveexec_b64 s[30:31], vcc
v_lshlrev_b32 v1, 4, v2
ds_write_b128 v1, v[12:15] offset:38976
s_mov_b64 exec, s[30:31]
s_waitcnt vmcnt(8)
v_lshrrev_b32 v4, 16, v4
v_lshrrev_b32 v5, 16, v5
v_lshrrev_b32 v6, 16, v6
v_lshrrev_b32 v7, 16, v7
v_max3_u32 v1, v4, v5, v6
v_max_u32 v1, v1, v7
v_cmp_lt_u32 vcc, 32, v1
s_cbranch_vccnz LB_slow
v_add3_u32 v4, v4, v5, v6
v_add_u32 v4, v4, v7
s_nop 1
v_add_u32_dpp v4, v4, v4 row_shr:1 row_mask:0xf bank_mask:0xf bound_ctrl:0
s_nop 1
v_add_u32_dpp v4, v4, v4 row_shr:2 row_mask:0xf bank_mask:0xf bound_ctrl:0
s_nop 1
v_add_u32_dpp v4, v4, v4 row_shr:4 row_mask:0xf bank_mask:0xf bound_ctrl:0
s_nop 1
v_add_u32_dpp v4, v4, v4 row_shr:8 row_mask:0xf bank_mask:0xf bound_ctrl:0
s_nop 1
v_add_u32_dpp v4, v4, v4 row_bcast:15 row_mask:0xa bank_mask:0xf
s_nop 1
v_add_u32_dpp v4, v4, v4 row_bcast:31 row_mask:0xc bank_mask:0xf
s_nop 1
v_readlane_b32 s30, v4, 63
s_cmp_gt_u32 s30, 4020
s_cbranch_scc1 LB_slow
v_and_b32 v10, 31, v2
s_lshl_b32 s29, s3, 4
v_add_u32 v11, s29, v9
v_mul_u32_u24 v11, 25024, v11
v_lshl_add_u32 v11, v10, 3, v11
s_mov_b32 s57, 50048
s_mov_b32 s58, 100096
s_mov_b32 s59, 150144
s_mov_b32 s60, 200192
s_mov_b32 s61, 250240
s_mov_b32 s62, 300288
s_mov_b32 s63, 350336
s_waitcnt vmcnt(0)
v_lshrrev_b32 v1, 16, v40
v_and_b32 v3, 0xffff, v40
v_lshl_add_u32 v3, v3, 3, v11
v_cmp_lt_u32 s[40:41], v10, v1
s_mov_b64 exec, s[40:41]
buffer_load_dwordx2 v[72:73], v3, s[20:23], 0 offen
s_mov_b64 exec, -1
v_lshrrev_b32 v1, 16, v41
v_and_b32 v3, 0xffff, v41
v_lshl_add_u32 v3, v3, 3, v11
v_cmp_lt_u32 s[42:43], v10, v1
s_mov_b64 exec, s[42:43]
buffer_load_dwordx2 v[74:75], v3, s[20:23], s57 offen
s_mov_b64 exec, -1
v_lshrrev_b32 v1, 16, v42
v_and_b32 v3, 0xffff, v42
v_lshl_add_u32 v3, v3, 3, v11
v_cmp_lt_u32 s[44:45], v10, v1
s_mov_b64 exec, s[44:45]
buffer_load_dwordx2 v[76:77], v3, s[20:23], s58 offen
s_mov_b64 exec, -1
v_lshrrev_b32 v1, 16, v43
v_and_b32 v3, 0xffff, v43
v_lshl_add_u32 v3, v3, 3, v11
v_cmp_lt_u32 s[46:47], v10, v1
s_mov_b64 exec, s[46:47]
buffer_load_dwordx2 v[78:79], v3, s[20:23], s59 offen
s_mov_b64 exec, -1
v_lshrrev_b32 v1, 16, v44
v_and_b32 v3, 0xffff, v44
v_lshl_add_u32 v3, v3, 3, v11
v_cmp_lt_u32 s[48:49], v10, v1
s_mov_b64 exec, s[48:49]
buffer_load_dwordx2 v[80:81], v3, s[20:23], s60 offen
s_mov_b64 exec, -1
v_lshrrev_b32 v1, 16, v45
v_and_b32 v3, 0xffff, v45
v_lshl_add_u32 v3, v3, 3, v11
v_cmp_lt_u32 s[50:51], v10, v1
s_mov_b64 exec, s[50:51]
buffer_load_dwordx2 v[82:83], v3, s[20:23], s61 offen
s_mov_b64 exec, -1
v_lshrrev_b32 v1, 16, v46
v_and_b32 v3, 0xffff, v46
v_lshl_add_u32 v3, v3, 3, v11
v_cmp_lt_u32 s[52:53], v10, v1
s_mov_b64 exec, s[52:53]
buffer_load_dwordx2 v[84:85], v3, s[20:23], s62 offen
s_mov_b64 exec, -1
v_lshrrev_b32 v1, 16, v47
v_and_b32 v3, 0xffff, v47
v_lshl_add_u32 v3, v3, 3, v11
v_cmp_lt_u32 s[54:55], v10, v1
s_mov_b64 exec, s[54:55]
buffer_load_dwordx2 v[86:87], v3, s[20:23], s63 offen
s_mov_b64 exec, -1
v_mov_b32 v1, 1
s_waitcnt vmcnt(7)
s_mov_b64 exec, s[40:41]
v_lshrrev_b32 v88, 16, v73
v_lshlrev_b32 v88, 2, v88
ds_add_rtn_u32 v96, v88, v1
s_waitcnt vmcnt(6)
s_mov_b64 exec, s[42:43]
v_lshrrev_b32 v89, 16, v75
v_lshlrev_b32 v89, 2, v89
ds_add_rtn_u32 v97, v89, v1
s_waitcnt vmcnt(5)
s_mov_b64 exec, s[44:45]
v_lshrrev_b32 v90, 16, v77
v_lshlrev_b32 v90, 2, v90
ds_add_rtn_u32 v98, v90, v1
s_waitcnt vmcnt(4)
s_mov_b64 exec, s[46:47]
v_lshrrev_b32 v91, 16, v79
v_lshlrev_b32 v91, 2, v91
ds_add_rtn_u32 v99, v91, v1
s_waitcnt vmcnt(3)
s_mov_b64 exec, s[48:49]
v_lshrrev_b32 v92, 16, v81
v_lshlrev_b32 v92, 2, v92
ds_add_rtn_u32 v100, v92, v1
s_waitcnt vmcnt(2)
s_mov_b64 exec, s[50:51]
v_lshrrev_b32 v93, 16, v83
v_lshlrev_b32 v93, 2, v93
ds_add_rtn_u32 v101, v93, v1
s_waitcnt vmcnt(1)
s_mov_b64 exec, s[52:53]
v_lshrrev_b32 v94, 16, v85
v_lshlrev_b32 v94, 2, v94
ds_add_rtn_u32 v102, v94, v1
s_waitcnt vmcnt(0)
s_mov_b64 exec, s[54:55]
v_lshrrev_b32 v95, 16, v87
v_lshlrev_b32 v95, 2, v95
ds_add_rtn_u32 v103, v95, v1
s_mov_b64 exec, -1
s_waitcnt lgkmcnt(0)
s_barrier
v_lshlrev_b32 v3, 4, v2
ds_read_b128 v[4:7], v3
s_waitcnt lgkmcnt(0)
v_add_u32 v4, 3, v4
v_and_b32 v4, -4, v4
v_add_u32 v5, 3, v5
v_and_b32 v5, -4, v5
v_add_u32 v6, 3, v6
v_and_b32 v6, -4, v6
v_add_u32 v7, 3, v7
v_and_b32 v7, -4, v7
v_add_u32 v12, v4, v5
v_add_u32 v13, v12, v6
v_add_u32 v14, v13, v7
s_nop 1
v_add_u32_dpp v14, v14, v14 row_shr:1 row_mask:0xf bank_mask:0xf bound_ctrl:0
s_nop 1
v_add_u32_dpp v14, v14, v14 row_shr:2 row_mask:0xf bank_mask:0xf bound_ctrl:0
s_nop 1
v_add_u32_dpp v14, v14, v14 row_shr:4 row_mask:0xf bank_mask:0xf bound_ctrl:0
s_nop 1
v_add_u32_dpp v14, v14, v14 row_shr:8 row_mask:0xf bank_mask:0xf bound_ctrl:0
s_nop 1
v_add_u32_dpp v14, v14, v14 row_bcast:15 row_mask:0xa bank_mask:0xf
s_nop 1
v_add_u32_dpp v14, v14, v14 row_bcast:31 row_mask:0xc bank_mask:0xf
s_nop 1
v_sub_u32 v16, v14, v13
v_sub_u32 v16, v16, v7
v_add_u32 v17, v16, v4
v_add_u32 v18, v16, v12
v_add_u32 v19, v16, v13
ds_write_b128 v3, v[16:19] offset:1024
v_readlane_b32 s30, v14, 63
s_lshr_b32 s31, s30, 2
v_cmp_eq_u32 vcc, 63, v2
s_and_saveexec_b64 s[32:33], vcc
ds_write_b32 v3, v14 offset:1040
s_mov_b64 exec, s[32:33]
s_mov_b64 exec, s[40:41]
ds_read_b32 v104, v88 offset:1024
s_mov_b64 exec, s[42:43]
ds_read_b32 v105, v89 offset:1024
s_mov_b64 exec, s[44:45]
ds_read_b32 v106, v90 offset:1024
s_mov_b64 exec, s[46:47]
ds_read_b32 v107, v91 offset:1024
s_mov_b64 exec, s[48:49]
ds_read_b32 v108, v92 offset:1024
s_mov_b64 exec, s[50:51]
ds_read_b32 v109, v93 offset:1024
s_mov_b64 exec, s[52:53]
ds_read_b32 v110, v94 offset:1024
s_mov_b64 exec, s[54:55]
ds_read_b32 v111, v95 offset:1024
s_waitcnt lgkmcnt(0)
s_mov_b64 exec, s[40:41]
v_add_u32 v1, v104, v96
v_lshlrev_b32 v1, 3, v1
ds_write_b64 v1, v[72:73] offset:2112
s_mov_b64 exec, s[42:43]
v_add_u32 v1, v105, v97
v_lshlrev_b32 v1, 3, v1
ds_write_b64 v1, v[74:75] offset:2112
s_mov_b64 exec, s[44:45]
v_add_u32 v1, v106, v98
v_lshlrev_b32 v1, 3, v1
ds_write_b64 v1, v[76:77] offset:2112
s_mov_b64 exec, s[46:47]
v_add_u32 v1, v107, v99
v_lshlrev_b32 v1, 3, v1
ds_write_b64 v1, v[78:79] offset:2112
s_mov_b64 exec, s[48:49]
v_add_u32 v1, v108, v100
v_lshlrev_b32 v1, 3, v1
ds_write_b64 v1, v[80:81] offset:2112
s_mov_b64 exec, s[50:51]
v_add_u32 v1, v109, v101
v_lshlrev_b32 v1, 3, v1
ds_write_b64 v1, v[82:83] offset:2112
s_mov_b64 exec, s[52:53]
v_add_u32 v1, v110, v102
v_lshlrev_b32 v1, 3, v1
ds_write_b64 v1, v[84:85] offset:2112
s_mov_b64 exec, s[54:55]
v_add_u32 v1, v111, v103
v_lshlrev_b32 v1, 3, v1
ds_write_b64 v1, v[86:87] offset:2112
s_mov_b64 exec, -1
s_waitcnt lgkmcnt(0)
s_barrier
v_lshrrev_b32 v1, 3, v2
s_lshl_b32 s29, s3, 3
v_add_u32 v46, s29, v1
v_add_u32 v3, 1, v46
v_mul_u32_u24 v10, s31, v46
v_lshrrev_b32 v10, 7, v10
v_mul_u32_u24 v11, s31, v3
v_lshrrev_b32 v11, 7, v11
v_lshlrev_b32 v4, 5, v10
v_lshlrev_b32 v5, 5, v11
v_max_u32 v6, 32, v5
ds_read_b32 v4, v4 offset:2116
ds_read_b32 v5, v5 offset:2116
ds_read_b32 v6, v6 offset:2084
s_waitcnt lgkmcnt(0)
v_lshrrev_b32 v47, 16, v4
v_lshrrev_b32 v5, 16, v5
v_lshrrev_b32 v6, 16, v6
v_cmp_eq_u32 vcc, v5, v6
v_cmp_gt_u32 s[40:41], s31, v11
s_and_b64 vcc, vcc, s[40:41]
v_cmp_lt_u32 s[40:41], 0, v11
s_and_b64 vcc, vcc, s[40:41]
v_mov_b32 v1, 0xff
v_cndmask_b32 v35, v1, v6, vcc
s_add_u32 s35, s31, 127
s_lshr_b32 s35, s35, 7
s_mov_b32 s36, 3
v_and_b32 v1, 7, v2
v_lshlrev_b32 v12, 4, v1
v_lshlrev_b32 v13, 5, v1
v_add_u32 v13, 39008, v13
v_mov_b32 v15, 1152
s_mov_b32 s34, 272
v_mov_b32 v16, 0
v_mov_b32 v17, 0
v_mov_b32 v18, 0
v_mov_b32 v19, 0
v_mov_b32 v20, 0
v_mov_b32 v21, 0
v_mov_b32 v22, 0
v_mov_b32 v23, 0
v_mov_b32 v72, 0
v_mov_b32 v73, 0
v_mov_b32 v74, 0
v_mov_b32 v75, 0
v_mov_b32 v76, 0
v_mov_b32 v77, 0
v_mov_b32 v78, 0
v_mov_b32 v79, 0
v_mov_b32 v80, 0
v_mov_b32 v81, 0
v_mov_b32 v82, 0
v_mov_b32 v83, 0
v_mov_b32 v84, 0
v_mov_b32 v85, 0
v_mov_b32 v86, 0
v_mov_b32 v87, 0
v_mov_b32 v88, 0
v_mov_b32 v89, 0
v_mov_b32 v90, 0
v_mov_b32 v91, 0
v_mov_b32 v92, 0
v_mov_b32 v93, 0
v_mov_b32 v94, 0
v_mov_b32 v95, 0
v_mov_b32 v96, 0
v_mov_b32 v97, 0
v_mov_b32 v98, 0
v_mov_b32 v99, 0
v_mov_b32 v100, 0
v_mov_b32 v101, 0
v_mov_b32 v102, 0
v_mov_b32 v103, 0
v_mov_b32 v104, 0
v_mov_b32 v105, 0
v_mov_b32 v106, 0
v_mov_b32 v107, 0
v_mov_b32 v108, 0
v_mov_b32 v109, 0
v_mov_b32 v110, 0
v_mov_b32 v111, 0
v_mov_b32 v112, 0
v_mov_b32 v113, 0
v_mov_b32 v114, 0
v_mov_b32 v115, 0
v_mov_b32 v116, 0
v_mov_b32 v117, 0
v_mov_b32 v118, 0
v_mov_b32 v119, 0
s_setprio 3
v_cmp_lt_u32 vcc, v10, v11
v_cndmask_b32 v14, v15, v10, vcc
v_lshlrev_b32 v14, 5, v14
v_add_u32 v10, 1, v10
ds_read_b128 v[48:51], v14 offset:2112
ds_read_b128 v[52:55], v14 offset:2128
v_cmp_lt_u32 vcc, v10, v11
v_cndmask_b32 v14, v15, v10, vcc
v_lshlrev_b32 v14, 5, v14
v_add_u32 v10, 1, v10
ds_read_b128 v[56:59], v14 offset:2112
ds_read_b128 v[60:63], v14 offset:2128
v_cmp_lt_u32 vcc, v10, v11
v_cndmask_b32 v14, v15, v10, vcc
v_lshlrev_b32 v14, 5, v14
v_add_u32 v10, 1, v10
ds_read_b128 v[64:67], v14 offset:2112
ds_read_b128 v[68:71], v14 offset:2128
s_waitcnt lgkmcnt(0)
v_lshrrev_b32 v32, 16, v49
v_cmp_eq_u32 vcc, 0xff, v32
v_cndmask_b32 v32, v32, v35, vcc
v_lshl_add_u32 v36, v48, 7, v12
v_lshl_add_u32 v37, v50, 7, v12
v_lshl_add_u32 v38, v52, 7, v12
v_lshl_add_u32 v39, v54, 7, v12
v_and_b32 v1, 0xffff, v49
v_cmp_ne_u32 s[40:41], 0, v1
v_and_b32 v1, 0xffff, v51
v_cmp_ne_u32 s[42:43], 0, v1
v_and_b32 v1, 0xffff, v53
v_cmp_ne_u32 s[44:45], 0, v1
v_and_b32 v1, 0xffff, v55
v_cmp_ne_u32 s[46:47], 0, v1
s_mov_b64 exec, s[40:41]
buffer_load_dwordx4 v[72:75], v36, s[8:11], 0 offen
s_mov_b64 exec, s[42:43]
buffer_load_dwordx4 v[76:79], v37, s[8:11], 0 offen
s_mov_b64 exec, s[44:45]
buffer_load_dwordx4 v[80:83], v38, s[8:11], 0 offen
s_mov_b64 exec, s[46:47]
buffer_load_dwordx4 v[84:87], v39, s[8:11], 0 offen
s_mov_b64 exec, -1
v_lshrrev_b32 v33, 16, v57
v_cmp_eq_u32 vcc, 0xff, v33
v_cndmask_b32 v33, v33, v35, vcc
v_lshl_add_u32 v36, v56, 7, v12
v_lshl_add_u32 v37, v58, 7, v12
v_lshl_add_u32 v38, v60, 7, v12
v_lshl_add_u32 v39, v62, 7, v12
v_and_b32 v1, 0xffff, v57
v_cmp_ne_u32 s[40:41], 0, v1
v_and_b32 v1, 0xffff, v59
v_cmp_ne_u32 s[42:43], 0, v1
v_and_b32 v1, 0xffff, v61
v_cmp_ne_u32 s[44:45], 0, v1
v_and_b32 v1, 0xffff, v63
v_cmp_ne_u32 s[46:47], 0, v1
s_mov_b64 exec, s[40:41]
buffer_load_dwordx4 v[88:91], v36, s[8:11], 0 offen
s_mov_b64 exec, s[42:43]
buffer_load_dwordx4 v[92:95], v37, s[8:11], 0 offen
s_mov_b64 exec, s[44:45]
buffer_load_dwordx4 v[96:99], v38, s[8:11], 0 offen
s_mov_b64 exec, s[46:47]
buffer_load_dwordx4 v[100:103], v39, s[8:11], 0 offen
s_mov_b64 exec, -1
v_lshrrev_b32 v34, 16, v65
v_cmp_eq_u32 vcc, 0xff, v34
v_cndmask_b32 v34, v34, v35, vcc
v_lshl_add_u32 v36, v64, 7, v12
v_lshl_add_u32 v37, v66, 7, v12
v_lshl_add_u32 v38, v68, 7, v12
v_lshl_add_u32 v39, v70, 7, v12
v_and_b32 v1, 0xffff, v65
v_cmp_ne_u32 s[40:41], 0, v1
v_and_b32 v1, 0xffff, v67
v_cmp_ne_u32 s[42:43], 0, v1
v_and_b32 v1, 0xffff, v69
v_cmp_ne_u32 s[44:45], 0, v1
v_and_b32 v1, 0xffff, v71
v_cmp_ne_u32 s[46:47], 0, v1
s_mov_b64 exec, s[40:41]
buffer_load_dwordx4 v[104:107], v36, s[8:11], 0 offen
s_mov_b64 exec, s[42:43]
buffer_load_dwordx4 v[108:111], v37, s[8:11], 0 offen
s_mov_b64 exec, s[44:45]
buffer_load_dwordx4 v[112:115], v38, s[8:11], 0 offen
s_mov_b64 exec, s[46:47]
buffer_load_dwordx4 v[116:119], v39, s[8:11], 0 offen
s_mov_b64 exec, -1
LF_loop:
s_cmp_ge_u32 s36, s35
s_cbranch_scc1 LF_epi0
s_add_u32 s36, s36, 1
s_cmp_lt_u32 s36, 6
s_cbranch_scc1 LF_sp0
s_setprio 2
LF_sp0:
v_and_b32 v24, 0xffff, v49
v_lshlrev_b32 v25, 16, v49
v_and_b32 v26, 0xffff, v51
v_lshlrev_b32 v27, 16, v51
v_and_b32 v28, 0xffff, v53
v_lshlrev_b32 v29, 16, v53
v_and_b32 v30, 0xffff, v55
v_lshlrev_b32 v31, 16, v55
v_cmp_lt_u32 vcc, v10, v11
v_cndmask_b32 v14, v15, v10, vcc
v_lshlrev_b32 v14, 5, v14
v_add_u32 v10, 1, v10
ds_read_b128 v[48:51], v14 offset:2112
ds_read_b128 v[52:55], v14 offset:2128
s_waitcnt vmcnt(8)
v_dot2c_f32_bf16 v16, v72, v24
v_dot2c_f32_bf16 v17, v72, v25
v_dot2c_f32_bf16 v18, v73, v24
v_dot2c_f32_bf16 v19, v73, v25
v_dot2c_f32_bf16 v20, v74, v24
v_dot2c_f32_bf16 v21, v74, v25
v_dot2c_f32_bf16 v22, v75, v24
v_dot2c_f32_bf16 v23, v75, v25
v_dot2c_f32_bf16 v16, v76, v26
v_dot2c_f32_bf16 v17, v76, v27
v_dot2c_f32_bf16 v18, v77, v26
v_dot2c_f32_bf16 v19, v77, v27
v_dot2c_f32_bf16 v20, v78, v26
v_dot2c_f32_bf16 v21, v78, v27
v_dot2c_f32_bf16 v22, v79, v26
v_dot2c_f32_bf16 v23, v79, v27
v_dot2c_f32_bf16 v16, v80, v28
v_dot2c_f32_bf16 v17, v80, v29
v_dot2c_f32_bf16 v18, v81, v28
v_dot2c_f32_bf16 v19, v81, v29
v_dot2c_f32_bf16 v20, v82, v28
v_dot2c_f32_bf16 v21, v82, v29
v_dot2c_f32_bf16 v22, v83, v28
v_dot2c_f32_bf16 v23, v83, v29
v_dot2c_f32_bf16 v16, v84, v30
v_dot2c_f32_bf16 v17, v84, v31
v_dot2c_f32_bf16 v18, v85, v30
v_dot2c_f32_bf16 v19, v85, v31
v_dot2c_f32_bf16 v20, v86, v30
v_dot2c_f32_bf16 v21, v86, v31
v_dot2c_f32_bf16 v22, v87, v30
v_dot2c_f32_bf16 v23, v87, v31
v_cmp_ne_u32 vcc, v32, v33
s_mov_b64 exec, vcc
v_mad_u32_u24 v14, v32, s34, v13
ds_write_b128 v14, v[16:19]
ds_write_b128 v14, v[20:23] offset:16
v_mov_b32 v16, 0
v_mov_b32 v17, 0
v_mov_b32 v18, 0
v_mov_b32 v19, 0
v_mov_b32 v20, 0
v_mov_b32 v21, 0
v_mov_b32 v22, 0
v_mov_b32 v23, 0
s_mov_b64 exec, -1
s_waitcnt lgkmcnt(2)
v_lshrrev_b32 v32, 16, v49
v_cmp_eq_u32 vcc, 0xff, v32
v_cndmask_b32 v32, v32, v35, vcc
v_lshl_add_u32 v36, v48, 7, v12
v_lshl_add_u32 v37, v50, 7, v12
v_lshl_add_u32 v38, v52, 7, v12
v_lshl_add_u32 v39, v54, 7, v12
v_and_b32 v1, 0xffff, v49
v_cmp_ne_u32 s[40:41], 0, v1
v_and_b32 v1, 0xffff, v51
v_cmp_ne_u32 s[42:43], 0, v1
v_and_b32 v1, 0xffff, v53
v_cmp_ne_u32 s[44:45], 0, v1
v_and_b32 v1, 0xffff, v55
v_cmp_ne_u32 s[46:47], 0, v1
s_mov_b64 exec, s[40:41]
buffer_load_dwordx4 v[72:75], v36, s[8:11], 0 offen
s_mov_b64 exec, s[42:43]
buffer_load_dwordx4 v[76:79], v37, s[8:11], 0 offen
s_mov_b64 exec, s[44:45]
buffer_load_dwordx4 v[80:83], v38, s[8:11], 0 offen
s_mov_b64 exec, s[46:47]
buffer_load_dwordx4 v[84:87], v39, s[8:11], 0 offen
s_mov_b64 exec, -1
s_cmp_ge_u32 s36, s35
s_cbranch_scc1 LF_epi1
s_add_u32 s36, s36, 1
s_cmp_lt_u32 s36, 6
s_cbranch_scc1 LF_sp1
s_setprio 2
LF_sp1:
v_and_b32 v24, 0xffff, v57
v_lshlrev_b32 v25, 16, v57
v_and_b32 v26, 0xffff, v59
v_lshlrev_b32 v27, 16, v59
v_and_b32 v28, 0xffff, v61
v_lshlrev_b32 v29, 16, v61
v_and_b32 v30, 0xffff, v63
v_lshlrev_b32 v31, 16, v63
v_cmp_lt_u32 vcc, v10, v11
v_cndmask_b32 v14, v15, v10, vcc
v_lshlrev_b32 v14, 5, v14
v_add_u32 v10, 1, v10
ds_read_b128 v[56:59], v14 offset:2112
ds_read_b128 v[60:63], v14 offset:2128
s_waitcnt vmcnt(8)
v_dot2c_f32_bf16 v16, v88, v24
v_dot2c_f32_bf16 v17, v88, v25
v_dot2c_f32_bf16 v18, v89, v24
v_dot2c_f32_bf16 v19, v89, v25
v_dot2c_f32_bf16 v20, v90, v24
v_dot2c_f32_bf16 v21, v90, v25
v_dot2c_f32_bf16 v22, v91, v24
v_dot2c_f32_bf16 v23, v91, v25
v_dot2c_f32_bf16 v16, v92, v26
v_dot2c_f32_bf16 v17, v92, v27
v_dot2c_f32_bf16 v18, v93, v26
v_dot2c_f32_bf16 v19, v93, v27
v_dot2c_f32_bf16 v20, v94, v26
v_dot2c_f32_bf16 v21, v94, v27
v_dot2c_f32_bf16 v22, v95, v26
v_dot2c_f32_bf16 v23, v95, v27
v_dot2c_f32_bf16 v16, v96, v28
v_dot2c_f32_bf16 v17, v96, v29
v_dot2c_f32_bf16 v18, v97, v28
v_dot2c_f32_bf16 v19, v97, v29
v_dot2c_f32_bf16 v20, v98, v28
v_dot2c_f32_bf16 v21, v98, v29
v_dot2c_f32_bf16 v22, v99, v28
v_dot2c_f32_bf16 v23, v99, v29
v_dot2c_f32_bf16 v16, v100, v30
v_dot2c_f32_bf16 v17, v100, v31
v_dot2c_f32_bf16 v18, v101, v30
v_dot2c_f32_bf16 v19, v101, v31
v_dot2c_f32_bf16 v20, v102, v30
v_dot2c_f32_bf16 v21, v102, v31
v_dot2c_f32_bf16 v22, v103, v30
v_dot2c_f32_bf16 v23, v103, v31
v_cmp_ne_u32 vcc, v33, v34
s_mov_b64 exec, vcc
v_mad_u32_u24 v14, v33, s34, v13
ds_write_b128 v14, v[16:19]
ds_write_b128 v14, v[20:23] offset:16
v_mov_b32 v16, 0
v_mov_b32 v17, 0
v_mov_b32 v18, 0
v_mov_b32 v19, 0
v_mov_b32 v20, 0
v_mov_b32 v21, 0
v_mov_b32 v22, 0
v_mov_b32 v23, 0
s_mov_b64 exec, -1
s_waitcnt lgkmcnt(2)
v_lshrrev_b32 v33, 16, v57
v_cmp_eq_u32 vcc, 0xff, v33
v_cndmask_b32 v33, v33, v35, vcc
v_lshl_add_u32 v36, v56, 7, v12
v_lshl_add_u32 v37, v58, 7, v12
v_lshl_add_u32 v38, v60, 7, v12
v_lshl_add_u32 v39, v62, 7, v12
v_and_b32 v1, 0xffff, v57
v_cmp_ne_u32 s[40:41], 0, v1
v_and_b32 v1, 0xffff, v59
v_cmp_ne_u32 s[42:43], 0, v1
v_and_b32 v1, 0xffff, v61
v_cmp_ne_u32 s[44:45], 0, v1
v_and_b32 v1, 0xffff, v63
v_cmp_ne_u32 s[46:47], 0, v1
s_mov_b64 exec, s[40:41]
buffer_load_dwordx4 v[88:91], v36, s[8:11], 0 offen
s_mov_b64 exec, s[42:43]
buffer_load_dwordx4 v[92:95], v37, s[8:11], 0 offen
s_mov_b64 exec, s[44:45]
buffer_load_dwordx4 v[96:99], v38, s[8:11], 0 offen
s_mov_b64 exec, s[46:47]
buffer_load_dwordx4 v[100:103], v39, s[8:11], 0 offen
s_mov_b64 exec, -1
s_cmp_ge_u32 s36, s35
s_cbranch_scc1 LF_epi2
s_add_u32 s36, s36, 1
s_cmp_lt_u32 s36, 6
s_cbranch_scc1 LF_sp2
s_setprio 2
LF_sp2:
v_and_b32 v24, 0xffff, v65
v_lshlrev_b32 v25, 16, v65
v_and_b32 v26, 0xffff, v67
v_lshlrev_b32 v27, 16, v67
v_and_b32 v28, 0xffff, v69
v_lshlrev_b32 v29, 16, v69
v_and_b32 v30, 0xffff, v71
v_lshlrev_b32 v31, 16, v71
v_cmp_lt_u32 vcc, v10, v11
v_cndmask_b32 v14, v15, v10, vcc
v_lshlrev_b32 v14, 5, v14
v_add_u32 v10, 1, v10
ds_read_b128 v[64:67], v14 offset:2112
ds_read_b128 v[68:71], v14 offset:2128
s_waitcnt vmcnt(8)
v_dot2c_f32_bf16 v16, v104, v24
v_dot2c_f32_bf16 v17, v104, v25
v_dot2c_f32_bf16 v18, v105, v24
v_dot2c_f32_bf16 v19, v105, v25
v_dot2c_f32_bf16 v20, v106, v24
v_dot2c_f32_bf16 v21, v106, v25
v_dot2c_f32_bf16 v22, v107, v24
v_dot2c_f32_bf16 v23, v107, v25
v_dot2c_f32_bf16 v16, v108, v26
v_dot2c_f32_bf16 v17, v108, v27
v_dot2c_f32_bf16 v18, v109, v26
v_dot2c_f32_bf16 v19, v109, v27
v_dot2c_f32_bf16 v20, v110, v26
v_dot2c_f32_bf16 v21, v110, v27
v_dot2c_f32_bf16 v22, v111, v26
v_dot2c_f32_bf16 v23, v111, v27
v_dot2c_f32_bf16 v16, v112, v28
v_dot2c_f32_bf16 v17, v112, v29
v_dot2c_f32_bf16 v18, v113, v28
v_dot2c_f32_bf16 v19, v113, v29
v_dot2c_f32_bf16 v20, v114, v28
v_dot2c_f32_bf16 v21, v114, v29
v_dot2c_f32_bf16 v22, v115, v28
v_dot2c_f32_bf16 v23, v115, v29
v_dot2c_f32_bf16 v16, v116, v30
v_dot2c_f32_bf16 v17, v116, v31
v_dot2c_f32_bf16 v18, v117, v30
v_dot2c_f32_bf16 v19, v117, v31
v_dot2c_f32_bf16 v20, v118, v30
v_dot2c_f32_bf16 v21, v118, v31
v_dot2c_f32_bf16 v22, v119, v30
v_dot2c_f32_bf16 v23, v119, v31
v_cmp_ne_u32 vcc, v34, v32
s_mov_b64 exec, vcc
v_mad_u32_u24 v14, v34, s34, v13
ds_write_b128 v14, v[16:19]
ds_write_b128 v14, v[20:23] offset:16
v_mov_b32 v16, 0
v_mov_b32 v17, 0
v_mov_b32 v18, 0
v_mov_b32 v19, 0
v_mov_b32 v20, 0
v_mov_b32 v21, 0
v_mov_b32 v22, 0
v_mov_b32 v23, 0
s_mov_b64 exec, -1
s_waitcnt lgkmcnt(2)
v_lshrrev_b32 v34, 16, v65
v_cmp_eq_u32 vcc, 0xff, v34
v_cndmask_b32 v34, v34, v35, vcc
v_lshl_add_u32 v36, v64, 7, v12
v_lshl_add_u32 v37, v66, 7, v12
v_lshl_add_u32 v38, v68, 7, v12
v_lshl_add_u32 v39, v70, 7, v12
v_and_b32 v1, 0xffff, v65
v_cmp_ne_u32 s[40:41], 0, v1
v_and_b32 v1, 0xffff, v67
v_cmp_ne_u32 s[42:43], 0, v1
v_and_b32 v1, 0xffff, v69
v_cmp_ne_u32 s[44:45], 0, v1
v_and_b32 v1, 0xffff, v71
v_cmp_ne_u32 s[46:47], 0, v1
s_mov_b64 exec, s[40:41]
buffer_load_dwordx4 v[104:107], v36, s[8:11], 0 offen
s_mov_b64 exec, s[42:43]
buffer_load_dwordx4 v[108:111], v37, s[8:11], 0 offen
s_mov_b64 exec, s[44:45]
buffer_load_dwordx4 v[112:115], v38, s[8:11], 0 offen
s_mov_b64 exec, s[46:47]
buffer_load_dwordx4 v[116:119], v39, s[8:11], 0 offen
s_mov_b64 exec, -1
s_branch LF_loop
LF_epi0:
s_setprio 1
v_and_b32 v24, 0xffff, v49
v_lshlrev_b32 v25, 16, v49
v_and_b32 v26, 0xffff, v51
v_lshlrev_b32 v27, 16, v51
v_and_b32 v28, 0xffff, v53
v_lshlrev_b32 v29, 16, v53
v_and_b32 v30, 0xffff, v55
v_lshlrev_b32 v31, 16, v55
s_waitcnt vmcnt(8)
v_dot2c_f32_bf16 v16, v72, v24
v_dot2c_f32_bf16 v17, v72, v25
v_dot2c_f32_bf16 v18, v73, v24
v_dot2c_f32_bf16 v19, v73, v25
v_dot2c_f32_bf16 v20, v74, v24
v_dot2c_f32_bf16 v21, v74, v25
v_dot2c_f32_bf16 v22, v75, v24
v_dot2c_f32_bf16 v23, v75, v25
v_dot2c_f32_bf16 v16, v76, v26
v_dot2c_f32_bf16 v17, v76, v27
v_dot2c_f32_bf16 v18, v77, v26
v_dot2c_f32_bf16 v19, v77, v27
v_dot2c_f32_bf16 v20, v78, v26
v_dot2c_f32_bf16 v21, v78, v27
v_dot2c_f32_bf16 v22, v79, v26
v_dot2c_f32_bf16 v23, v79, v27
v_dot2c_f32_bf16 v16, v80, v28
v_dot2c_f32_bf16 v17, v80, v29
v_dot2c_f32_bf16 v18, v81, v28
v_dot2c_f32_bf16 v19, v81, v29
v_dot2c_f32_bf16 v20, v82, v28
v_dot2c_f32_bf16 v21, v82, v29
v_dot2c_f32_bf16 v22, v83, v28
v_dot2c_f32_bf16 v23, v83, v29
v_dot2c_f32_bf16 v16, v84, v30
v_dot2c_f32_bf16 v17, v84, v31
v_dot2c_f32_bf16 v18, v85, v30
v_dot2c_f32_bf16 v19, v85, v31
v_dot2c_f32_bf16 v20, v86, v30
v_dot2c_f32_bf16 v21, v86, v31
v_dot2c_f32_bf16 v22, v87, v30
v_dot2c_f32_bf16 v23, v87, v31
v_cmp_ne_u32 vcc, v32, v33
s_mov_b64 exec, vcc
v_mad_u32_u24 v14, v32, s34, v13
ds_write_b128 v14, v[16:19]
ds_write_b128 v14, v[20:23] offset:16
v_mov_b32 v16, 0
v_mov_b32 v17, 0
v_mov_b32 v18, 0
v_mov_b32 v19, 0
v_mov_b32 v20, 0
v_mov_b32 v21, 0
v_mov_b32 v22, 0
v_mov_b32 v23, 0
s_mov_b64 exec, -1
s_setprio 0
v_and_b32 v24, 0xffff, v57
v_lshlrev_b32 v25, 16, v57
v_and_b32 v26, 0xffff, v59
v_lshlrev_b32 v27, 16, v59
v_and_b32 v28, 0xffff, v61
v_lshlrev_b32 v29, 16, v61
v_and_b32 v30, 0xffff, v63
v_lshlrev_b32 v31, 16, v63
s_waitcnt vmcnt(4)
v_dot2c_f32_bf16 v16, v88, v24
v_dot2c_f32_bf16 v17, v88, v25
v_dot2c_f32_bf16 v18, v89, v24
v_dot2c_f32_bf16 v19, v89, v25
v_dot2c_f32_bf16 v20, v90, v24
v_dot2c_f32_bf16 v21, v90, v25
v_dot2c_f32_bf16 v22, v91, v24
v_dot2c_f32_bf16 v23, v91, v25
v_dot2c_f32_bf16 v16, v92, v26
v_dot2c_f32_bf16 v17, v92, v27
v_dot2c_f32_bf16 v18, v93, v26
v_dot2c_f32_bf16 v19, v93, v27
v_dot2c_f32_bf16 v20, v94, v26
v_dot2c_f32_bf16 v21, v94, v27
v_dot2c_f32_bf16 v22, v95, v26
v_dot2c_f32_bf16 v23, v95, v27
v_dot2c_f32_bf16 v16, v96, v28
v_dot2c_f32_bf16 v17, v96, v29
v_dot2c_f32_bf16 v18, v97, v28
v_dot2c_f32_bf16 v19, v97, v29
v_dot2c_f32_bf16 v20, v98, v28
v_dot2c_f32_bf16 v21, v98, v29
v_dot2c_f32_bf16 v22, v99, v28
v_dot2c_f32_bf16 v23, v99, v29
v_dot2c_f32_bf16 v16, v100, v30
v_dot2c_f32_bf16 v17, v100, v31
v_dot2c_f32_bf16 v18, v101, v30
v_dot2c_f32_bf16 v19, v101, v31
v_dot2c_f32_bf16 v20, v102, v30
v_dot2c_f32_bf16 v21, v102, v31
v_dot2c_f32_bf16 v22, v103, v30
v_dot2c_f32_bf16 v23, v103, v31
v_cmp_ne_u32 vcc, v33, v34
s_mov_b64 exec, vcc
v_mad_u32_u24 v14, v33, s34, v13
ds_write_b128 v14, v[16:19]
ds_write_b128 v14, v[20:23] offset:16
v_mov_b32 v16, 0
v_mov_b32 v17, 0
v_mov_b32 v18, 0
v_mov_b32 v19, 0
v_mov_b32 v20, 0
v_mov_b32 v21, 0
v_mov_b32 v22, 0
v_mov_b32 v23, 0
s_mov_b64 exec, -1
v_and_b32 v24, 0xffff, v65
v_lshlrev_b32 v25, 16, v65
v_and_b32 v26, 0xffff, v67
v_lshlrev_b32 v27, 16, v67
v_and_b32 v28, 0xffff, v69
v_lshlrev_b32 v29, 16, v69
v_and_b32 v30, 0xffff, v71
v_lshlrev_b32 v31, 16, v71
s_waitcnt vmcnt(0)
v_dot2c_f32_bf16 v16, v104, v24
v_dot2c_f32_bf16 v17, v104, v25
v_dot2c_f32_bf16 v18, v105, v24
v_dot2c_f32_bf16 v19, v105, v25
v_dot2c_f32_bf16 v20, v106, v24
v_dot2c_f32_bf16 v21, v106, v25
v_dot2c_f32_bf16 v22, v107, v24
v_dot2c_f32_bf16 v23, v107, v25
v_dot2c_f32_bf16 v16, v108, v26
v_dot2c_f32_bf16 v17, v108, v27
v_dot2c_f32_bf16 v18, v109, v26
v_dot2c_f32_bf16 v19, v109, v27
v_dot2c_f32_bf16 v20, v110, v26
v_dot2c_f32_bf16 v21, v110, v27
v_dot2c_f32_bf16 v22, v111, v26
v_dot2c_f32_bf16 v23, v111, v27
v_dot2c_f32_bf16 v16, v112, v28
v_dot2c_f32_bf16 v17, v112, v29
v_dot2c_f32_bf16 v18, v113, v28
v_dot2c_f32_bf16 v19, v113, v29
v_dot2c_f32_bf16 v20, v114, v28
v_dot2c_f32_bf16 v21, v114, v29
v_dot2c_f32_bf16 v22, v115, v28
v_dot2c_f32_bf16 v23, v115, v29
v_dot2c_f32_bf16 v16, v116, v30
v_dot2c_f32_bf16 v17, v116, v31
v_dot2c_f32_bf16 v18, v117, v30
v_dot2c_f32_bf16 v19, v117, v31
v_dot2c_f32_bf16 v20, v118, v30
v_dot2c_f32_bf16 v21, v118, v31
v_dot2c_f32_bf16 v22, v119, v30
v_dot2c_f32_bf16 v23, v119, v31
v_cmp_ne_u32 vcc, v34, v35
s_mov_b64 exec, vcc
v_mad_u32_u24 v14, v34, s34, v13
ds_write_b128 v14, v[16:19]
ds_write_b128 v14, v[20:23] offset:16
v_mov_b32 v16, 0
v_mov_b32 v17, 0
v_mov_b32 v18, 0
v_mov_b32 v19, 0
v_mov_b32 v20, 0
v_mov_b32 v21, 0
v_mov_b32 v22, 0
v_mov_b32 v23, 0
s_mov_b64 exec, -1
s_branch LF_done
LF_epi1:
s_setprio 1
v_and_b32 v24, 0xffff, v57
v_lshlrev_b32 v25, 16, v57
v_and_b32 v26, 0xffff, v59
v_lshlrev_b32 v27, 16, v59
v_and_b32 v28, 0xffff, v61
v_lshlrev_b32 v29, 16, v61
v_and_b32 v30, 0xffff, v63
v_lshlrev_b32 v31, 16, v63
s_waitcnt vmcnt(8)
v_dot2c_f32_bf16 v16, v88, v24
v_dot2c_f32_bf16 v17, v88, v25
v_dot2c_f32_bf16 v18, v89, v24
v_dot2c_f32_bf16 v19, v89, v25
v_dot2c_f32_bf16 v20, v90, v24
v_dot2c_f32_bf16 v21, v90, v25
v_dot2c_f32_bf16 v22, v91, v24
v_dot2c_f32_bf16 v23, v91, v25
v_dot2c_f32_bf16 v16, v92, v26
v_dot2c_f32_bf16 v17, v92, v27
v_dot2c_f32_bf16 v18, v93, v26
v_dot2c_f32_bf16 v19, v93, v27
v_dot2c_f32_bf16 v20, v94, v26
v_dot2c_f32_bf16 v21, v94, v27
v_dot2c_f32_bf16 v22, v95, v26
v_dot2c_f32_bf16 v23, v95, v27
v_dot2c_f32_bf16 v16, v96, v28
v_dot2c_f32_bf16 v17, v96, v29
v_dot2c_f32_bf16 v18, v97, v28
v_dot2c_f32_bf16 v19, v97, v29
v_dot2c_f32_bf16 v20, v98, v28
v_dot2c_f32_bf16 v21, v98, v29
v_dot2c_f32_bf16 v22, v99, v28
v_dot2c_f32_bf16 v23, v99, v29
v_dot2c_f32_bf16 v16, v100, v30
v_dot2c_f32_bf16 v17, v100, v31
v_dot2c_f32_bf16 v18, v101, v30
v_dot2c_f32_bf16 v19, v101, v31
v_dot2c_f32_bf16 v20, v102, v30
v_dot2c_f32_bf16 v21, v102, v31
v_dot2c_f32_bf16 v22, v103, v30
v_dot2c_f32_bf16 v23, v103, v31
v_cmp_ne_u32 vcc, v33, v34
s_mov_b64 exec, vcc
v_mad_u32_u24 v14, v33, s34, v13
ds_write_b128 v14, v[16:19]
ds_write_b128 v14, v[20:23] offset:16
v_mov_b32 v16, 0
v_mov_b32 v17, 0
v_mov_b32 v18, 0
v_mov_b32 v19, 0
v_mov_b32 v20, 0
v_mov_b32 v21, 0
v_mov_b32 v22, 0
v_mov_b32 v23, 0
s_mov_b64 exec, -1
s_setprio 0
v_and_b32 v24, 0xffff, v65
v_lshlrev_b32 v25, 16, v65
v_and_b32 v26, 0xffff, v67
v_lshlrev_b32 v27, 16, v67
v_and_b32 v28, 0xffff, v69
v_lshlrev_b32 v29, 16, v69
v_and_b32 v30, 0xffff, v71
v_lshlrev_b32 v31, 16, v71
s_waitcnt vmcnt(4)
v_dot2c_f32_bf16 v16, v104, v24
v_dot2c_f32_bf16 v17, v104, v25
v_dot2c_f32_bf16 v18, v105, v24
v_dot2c_f32_bf16 v19, v105, v25
v_dot2c_f32_bf16 v20, v106, v24
v_dot2c_f32_bf16 v21, v106, v25
v_dot2c_f32_bf16 v22, v107, v24
v_dot2c_f32_bf16 v23, v107, v25
v_dot2c_f32_bf16 v16, v108, v26
v_dot2c_f32_bf16 v17, v108, v27
v_dot2c_f32_bf16 v18, v109, v26
v_dot2c_f32_bf16 v19, v109, v27
v_dot2c_f32_bf16 v20, v110, v26
v_dot2c_f32_bf16 v21, v110, v27
v_dot2c_f32_bf16 v22, v111, v26
v_dot2c_f32_bf16 v23, v111, v27
v_dot2c_f32_bf16 v16, v112, v28
v_dot2c_f32_bf16 v17, v112, v29
v_dot2c_f32_bf16 v18, v113, v28
v_dot2c_f32_bf16 v19, v113, v29
v_dot2c_f32_bf16 v20, v114, v28
v_dot2c_f32_bf16 v21, v114, v29
v_dot2c_f32_bf16 v22, v115, v28
v_dot2c_f32_bf16 v23, v115, v29
v_dot2c_f32_bf16 v16, v116, v30
v_dot2c_f32_bf16 v17, v116, v31
v_dot2c_f32_bf16 v18, v117, v30
v_dot2c_f32_bf16 v19, v117, v31
v_dot2c_f32_bf16 v20, v118, v30
v_dot2c_f32_bf16 v21, v118, v31
v_dot2c_f32_bf16 v22, v119, v30
v_dot2c_f32_bf16 v23, v119, v31
v_cmp_ne_u32 vcc, v34, v32
s_mov_b64 exec, vcc
v_mad_u32_u24 v14, v34, s34, v13
ds_write_b128 v14, v[16:19]
ds_write_b128 v14, v[20:23] offset:16
v_mov_b32 v16, 0
v_mov_b32 v17, 0
v_mov_b32 v18, 0
v_mov_b32 v19, 0
v_mov_b32 v20, 0
v_mov_b32 v21, 0
v_mov_b32 v22, 0
v_mov_b32 v23, 0
s_mov_b64 exec, -1
v_and_b32 v24, 0xffff, v49
v_lshlrev_b32 v25, 16, v49
v_and_b32 v26, 0xffff, v51
v_lshlrev_b32 v27, 16, v51
v_and_b32 v28, 0xffff, v53
v_lshlrev_b32 v29, 16, v53
v_and_b32 v30, 0xffff, v55
v_lshlrev_b32 v31, 16, v55
s_waitcnt vmcnt(0)
v_dot2c_f32_bf16 v16, v72, v24
v_dot2c_f32_bf16 v17, v72, v25
v_dot2c_f32_bf16 v18, v73, v24
v_dot2c_f32_bf16 v19, v73, v25
v_dot2c_f32_bf16 v20, v74, v24
v_dot2c_f32_bf16 v21, v74, v25
v_dot2c_f32_bf16 v22, v75, v24
v_dot2c_f32_bf16 v23, v75, v25
v_dot2c_f32_bf16 v16, v76, v26
v_dot2c_f32_bf16 v17, v76, v27
v_dot2c_f32_bf16 v18, v77, v26
v_dot2c_f32_bf16 v19, v77, v27
v_dot2c_f32_bf16 v20, v78, v26
v_dot2c_f32_bf16 v21, v78, v27
v_dot2c_f32_bf16 v22, v79, v26
v_dot2c_f32_bf16 v23, v79, v27
v_dot2c_f32_bf16 v16, v80, v28
v_dot2c_f32_bf16 v17, v80, v29
v_dot2c_f32_bf16 v18, v81, v28
v_dot2c_f32_bf16 v19, v81, v29
v_dot2c_f32_bf16 v20, v82, v28
v_dot2c_f32_bf16 v21, v82, v29
v_dot2c_f32_bf16 v22, v83, v28
v_dot2c_f32_bf16 v23, v83, v29
v_dot2c_f32_bf16 v16, v84, v30
v_dot2c_f32_bf16 v17, v84, v31
v_dot2c_f32_bf16 v18, v85, v30
v_dot2c_f32_bf16 v19, v85, v31
v_dot2c_f32_bf16 v20, v86, v30
v_dot2c_f32_bf16 v21, v86, v31
v_dot2c_f32_bf16 v22, v87, v30
v_dot2c_f32_bf16 v23, v87, v31
v_cmp_ne_u32 vcc, v32, v35
s_mov_b64 exec, vcc
v_mad_u32_u24 v14, v32, s34, v13
ds_write_b128 v14, v[16:19]
ds_write_b128 v14, v[20:23] offset:16
v_mov_b32 v16, 0
v_mov_b32 v17, 0
v_mov_b32 v18, 0
v_mov_b32 v19, 0
v_mov_b32 v20, 0
v_mov_b32 v21, 0
v_mov_b32 v22, 0
v_mov_b32 v23, 0
s_mov_b64 exec, -1
s_branch LF_done
LF_epi2:
s_setprio 1
v_and_b32 v24, 0xffff, v65
v_lshlrev_b32 v25, 16, v65
v_and_b32 v26, 0xffff, v67
v_lshlrev_b32 v27, 16, v67
v_and_b32 v28, 0xffff, v69
v_lshlrev_b32 v29, 16, v69
v_and_b32 v30, 0xffff, v71
v_lshlrev_b32 v31, 16, v71
s_waitcnt vmcnt(8)
v_dot2c_f32_bf16 v16, v104, v24
v_dot2c_f32_bf16 v17, v104, v25
v_dot2c_f32_bf16 v18, v105, v24
v_dot2c_f32_bf16 v19, v105, v25
v_dot2c_f32_bf16 v20, v106, v24
v_dot2c_f32_bf16 v21, v106, v25
v_dot2c_f32_bf16 v22, v107, v24
v_dot2c_f32_bf16 v23, v107, v25
v_dot2c_f32_bf16 v16, v108, v26
v_dot2c_f32_bf16 v17, v108, v27
v_dot2c_f32_bf16 v18, v109, v26
v_dot2c_f32_bf16 v19, v109, v27
v_dot2c_f32_bf16 v20, v110, v26
v_dot2c_f32_bf16 v21, v110, v27
v_dot2c_f32_bf16 v22, v111, v26
v_dot2c_f32_bf16 v23, v111, v27
v_dot2c_f32_bf16 v16, v112, v28
v_dot2c_f32_bf16 v17, v112, v29
v_dot2c_f32_bf16 v18, v113, v28
v_dot2c_f32_bf16 v19, v113, v29
v_dot2c_f32_bf16 v20, v114, v28
v_dot2c_f32_bf16 v21, v114, v29
v_dot2c_f32_bf16 v22, v115, v28
v_dot2c_f32_bf16 v23, v115, v29
v_dot2c_f32_bf16 v16, v116, v30
v_dot2c_f32_bf16 v17, v116, v31
v_dot2c_f32_bf16 v18, v117, v30
v_dot2c_f32_bf16 v19, v117, v31
v_dot2c_f32_bf16 v20, v118, v30
v_dot2c_f32_bf16 v21, v118, v31
v_dot2c_f32_bf16 v22, v119, v30
v_dot2c_f32_bf16 v23, v119, v31
v_cmp_ne_u32 vcc, v34, v32
s_mov_b64 exec, vcc
v_mad_u32_u24 v14, v34, s34, v13
ds_write_b128 v14, v[16:19]
ds_write_b128 v14, v[20:23] offset:16
v_mov_b32 v16, 0
v_mov_b32 v17, 0
v_mov_b32 v18, 0
v_mov_b32 v19, 0
v_mov_b32 v20, 0
v_mov_b32 v21, 0
v_mov_b32 v22, 0
v_mov_b32 v23, 0
s_mov_b64 exec, -1
s_setprio 0
v_and_b32 v24, 0xffff, v49
v_lshlrev_b32 v25, 16, v49
v_and_b32 v26, 0xffff, v51
v_lshlrev_b32 v27, 16, v51
v_and_b32 v28, 0xffff, v53
v_lshlrev_b32 v29, 16, v53
v_and_b32 v30, 0xffff, v55
v_lshlrev_b32 v31, 16, v55
s_waitcnt vmcnt(4)
v_dot2c_f32_bf16 v16, v72, v24
v_dot2c_f32_bf16 v17, v72, v25
v_dot2c_f32_bf16 v18, v73, v24
v_dot2c_f32_bf16 v19, v73, v25
v_dot2c_f32_bf16 v20, v74, v24
v_dot2c_f32_bf16 v21, v74, v25
v_dot2c_f32_bf16 v22, v75, v24
v_dot2c_f32_bf16 v23, v75, v25
v_dot2c_f32_bf16 v16, v76, v26
v_dot2c_f32_bf16 v17, v76, v27
v_dot2c_f32_bf16 v18, v77, v26
v_dot2c_f32_bf16 v19, v77, v27
v_dot2c_f32_bf16 v20, v78, v26
v_dot2c_f32_bf16 v21, v78, v27
v_dot2c_f32_bf16 v22, v79, v26
v_dot2c_f32_bf16 v23, v79, v27
v_dot2c_f32_bf16 v16, v80, v28
v_dot2c_f32_bf16 v17, v80, v29
v_dot2c_f32_bf16 v18, v81, v28
v_dot2c_f32_bf16 v19, v81, v29
v_dot2c_f32_bf16 v20, v82, v28
v_dot2c_f32_bf16 v21, v82, v29
v_dot2c_f32_bf16 v22, v83, v28
v_dot2c_f32_bf16 v23, v83, v29
v_dot2c_f32_bf16 v16, v84, v30
v_dot2c_f32_bf16 v17, v84, v31
v_dot2c_f32_bf16 v18, v85, v30
v_dot2c_f32_bf16 v19, v85, v31
v_dot2c_f32_bf16 v20, v86, v30
v_dot2c_f32_bf16 v21, v86, v31
v_dot2c_f32_bf16 v22, v87, v30
v_dot2c_f32_bf16 v23, v87, v31
v_cmp_ne_u32 vcc, v32, v33
s_mov_b64 exec, vcc
v_mad_u32_u24 v14, v32, s34, v13
ds_write_b128 v14, v[16:19]
ds_write_b128 v14, v[20:23] offset:16
v_mov_b32 v16, 0
v_mov_b32 v17, 0
v_mov_b32 v18, 0
v_mov_b32 v19, 0
v_mov_b32 v20, 0
v_mov_b32 v21, 0
v_mov_b32 v22, 0
v_mov_b32 v23, 0
s_mov_b64 exec, -1
v_and_b32 v24, 0xffff, v57
v_lshlrev_b32 v25, 16, v57
v_and_b32 v26, 0xffff, v59
v_lshlrev_b32 v27, 16, v59
v_and_b32 v28, 0xffff, v61
v_lshlrev_b32 v29, 16, v61
v_and_b32 v30, 0xffff, v63
v_lshlrev_b32 v31, 16, v63
s_waitcnt vmcnt(0)
v_dot2c_f32_bf16 v16, v88, v24
v_dot2c_f32_bf16 v17, v88, v25
v_dot2c_f32_bf16 v18, v89, v24
v_dot2c_f32_bf16 v19, v89, v25
v_dot2c_f32_bf16 v20, v90, v24
v_dot2c_f32_bf16 v21, v90, v25
v_dot2c_f32_bf16 v22, v91, v24
v_dot2c_f32_bf16 v23, v91, v25
v_dot2c_f32_bf16 v16, v92, v26
v_dot2c_f32_bf16 v17, v92, v27
v_dot2c_f32_bf16 v18, v93, v26
v_dot2c_f32_bf16 v19, v93, v27
v_dot2c_f32_bf16 v20, v94, v26
v_dot2c_f32_bf16 v21, v94, v27
v_dot2c_f32_bf16 v22, v95, v26
v_dot2c_f32_bf16 v23, v95, v27
v_dot2c_f32_bf16 v16, v96, v28
v_dot2c_f32_bf16 v17, v96, v29
v_dot2c_f32_bf16 v18, v97, v28
v_dot2c_f32_bf16 v19, v97, v29
v_dot2c_f32_bf16 v20, v98, v28
v_dot2c_f32_bf16 v21, v98, v29
v_dot2c_f32_bf16 v22, v99, v28
v_dot2c_f32_bf16 v23, v99, v29
v_dot2c_f32_bf16 v16, v100, v30
v_dot2c_f32_bf16 v17, v100, v31
v_dot2c_f32_bf16 v18, v101, v30
v_dot2c_f32_bf16 v19, v101, v31
v_dot2c_f32_bf16 v20, v102, v30
v_dot2c_f32_bf16 v21, v102, v31
v_dot2c_f32_bf16 v22, v103, v30
v_dot2c_f32_bf16 v23, v103, v31
v_cmp_ne_u32 vcc, v33, v35
s_mov_b64 exec, vcc
v_mad_u32_u24 v14, v33, s34, v13
ds_write_b128 v14, v[16:19]
ds_write_b128 v14, v[20:23] offset:16
v_mov_b32 v16, 0
v_mov_b32 v17, 0
v_mov_b32 v18, 0
v_mov_b32 v19, 0
v_mov_b32 v20, 0
v_mov_b32 v21, 0
v_mov_b32 v22, 0
v_mov_b32 v23, 0
s_mov_b64 exec, -1
LF_done:
s_setprio 0
v_lshlrev_b32 v14, 8, v46
v_and_b32 v1, 7, v2
v_lshl_add_u32 v14, v1, 5, v14
v_add_u32 v14, 99936, v14
ds_write_b128 v14, v[16:19]
ds_write_b128 v14, v[20:23] offset:16
v_lshlrev_b32 v3, 2, v46
v_add_u32 v3, 132704, v3
ds_write_b32 v3, v35
s_waitcnt vmcnt(0)
s_cmp_ge_u32 s3, 14
s_cbranch_scc1 LF_nold
s_lshr_b32 s28, s3, 1
s_lshl_b32 s28, s28, 5
v_and_b32 v10, 31, v2
v_lshrrev_b32 v11, 5, v2
v_add_u32 v16, s28, v10
s_mul_i32 s29, s2, 196
v_add_u32 v17, s29, v16
v_lshlrev_b32 v17, 7, v17
v_lshl_add_u32 v18, v11, 4, v17
s_and_b32 s28, s3, 1
s_lshl_b32 s28, s28, 13
s_add_u32 s28, s28, 6668288
v_lshlrev_b32 v19, 8, v10
v_lshl_add_u32 v19, v11, 4, v19
buffer_load_dwordx4 v[96:99], v18, s[8:11], 0 offen offset:0
buffer_load_dwordx4 v[100:103], v18, s[8:11], 0 offen offset:32
buffer_load_dwordx4 v[104:107], v18, s[8:11], 0 offen offset:64
buffer_load_dwordx4 v[108:111], v18, s[8:11], 0 offen offset:96
buffer_load_dwordx4 v[64:67], v19, s[20:23], s28 offen offset:0
buffer_load_dwordx4 v[68:71], v19, s[20:23], s28 offen offset:32
buffer_load_dwordx4 v[72:75], v19, s[20:23], s28 offen offset:64
buffer_load_dwordx4 v[76:79], v19, s[20:23], s28 offen offset:96
buffer_load_dwordx4 v[80:83], v19, s[20:23], s28 offen offset:128
buffer_load_dwordx4 v[84:87], v19, s[20:23], s28 offen offset:160
buffer_load_dwordx4 v[88:91], v19, s[20:23], s28 offen offset:192
buffer_load_dwordx4 v[92:95], v19, s[20:23], s28 offen offset:224
LF_nold:
s_waitcnt lgkmcnt(0)
s_barrier
v_lshrrev_b32 v1, 3, v2
s_lshl_b32 s29, s3, 3
v_add_u32 v40, s29, v1
v_add_u32 v41, 1, v40
v_mul_u32_u24 v42, s31, v40
v_lshrrev_b32 v42, 7, v42
v_mul_u32_u24 v43, s31, v41
v_lshrrev_b32 v43, 7, v43
v_cmp_lt_u32 vcc, v42, v43
v_cmp_ne_u32 s[40:41], v35, v47
s_and_b64 vcc, vcc, s[40:41]
v_cmp_lt_u32 s[40:41], 0, v40
s_and_b64 exec, vcc, s[40:41]
s_cbranch_execz LF_cdone
v_mad_u32_u24 v44, v47, s34, v13
ds_read_b128 v[48:51], v44
ds_read_b128 v[52:55], v44 offset:16
v_and_b32 v1, 7, v2
v_lshlrev_b32 v45, 5, v1
v_add_u32 v45, 99936, v45
LF_cl:
v_subrev_u32 v40, 1, v40
v_lshlrev_b32 v3, 2, v40
v_add_u32 v3, 132704, v3
ds_read_b32 v3, v3
s_waitcnt lgkmcnt(0)
v_cmp_eq_u32 vcc, v3, v47
s_and_b64 exec, exec, vcc
s_cbranch_execz LF_cdone
v_lshl_add_u32 v3, v40, 8, v45
ds_read_b128 v[56:59], v3
ds_read_b128 v[60:63], v3 offset:16
s_waitcnt lgkmcnt(0)
v_add_f32 v48, v48, v56
v_add_f32 v49, v49, v57
v_add_f32 v50, v50, v58
v_add_f32 v51, v51, v59
v_add_f32 v52, v52, v60
v_add_f32 v53, v53, v61
v_add_f32 v54, v54, v62
v_add_f32 v55, v55, v63
ds_write_b128 v44, v[48:51]
ds_write_b128 v44, v[52:55] offset:16
v_cmp_lt_u32 vcc, 0, v40
s_and_b64 exec, exec, vcc
s_cbranch_execnz LF_cl
LF_cdone:
s_mov_b64 exec, -1
s_waitcnt lgkmcnt(0)
s_barrier
s_cmp_ge_u32 s3, 14
s_cbranch_scc1 LB_end
v_mul_u32_u24 v19, 272, v16
v_lshl_add_u32 v19, v11, 5, v19
v_add_u32 v19, 39008, v19
ds_read_b128 v[24:27], v19 offset:0
ds_read_b128 v[28:31], v19 offset:16
ds_read_b128 v[32:35], v19 offset:64
ds_read_b128 v[36:39], v19 offset:80
ds_read_b128 v[40:43], v19 offset:128
ds_read_b128 v[44:47], v19 offset:144
ds_read_b128 v[48:51], v19 offset:192
ds_read_b128 v[52:55], v19 offset:208
s_waitcnt lgkmcnt(0)
v_cvt_pk_bf16_f32 v112, v24, v25
v_cvt_pk_bf16_f32 v113, v26, v27
v_cvt_pk_bf16_f32 v114, v28, v29
v_cvt_pk_bf16_f32 v115, v30, v31
v_cvt_pk_bf16_f32 v116, v32, v33
v_cvt_pk_bf16_f32 v117, v34, v35
v_cvt_pk_bf16_f32 v118, v36, v37
v_cvt_pk_bf16_f32 v119, v38, v39
v_cvt_pk_bf16_f32 v120, v40, v41
v_cvt_pk_bf16_f32 v121, v42, v43
v_cvt_pk_bf16_f32 v122, v44, v45
v_cvt_pk_bf16_f32 v123, v46, v47
v_cvt_pk_bf16_f32 v124, v48, v49
v_cvt_pk_bf16_f32 v125, v50, v51
v_cvt_pk_bf16_f32 v126, v52, v53
v_cvt_pk_bf16_f32 v127, v54, v55
v_mov_b32 v24, 0
v_mov_b32 v25, 0
v_mov_b32 v26, 0
v_mov_b32 v27, 0
v_mov_b32 v28, 0
v_mov_b32 v29, 0
v_mov_b32 v30, 0
v_mov_b32 v31, 0
v_mov_b32 v32, 0
v_mov_b32 v33, 0
v_mov_b32 v34, 0
v_mov_b32 v35, 0
v_mov_b32 v36, 0
v_mov_b32 v37, 0
v_mov_b32 v38, 0
v_mov_b32 v39, 0
s_waitcnt vmcnt(0) lgkmcnt(0)
s_nop 1
v_mfma_f32_32x32x16_bf16 v[24:39], v[64:67], v[96:99], v[24:39]
v_mfma_f32_32x32x16_bf16 v[24:39], v[68:71], v[100:103], v[24:39]
v_mfma_f32_32x32x16_bf16 v[24:39], v[72:75], v[104:107], v[24:39]
v_mfma_f32_32x32x16_bf16 v[24:39], v[76:79], v[108:111], v[24:39]
v_mfma_f32_32x32x16_bf16 v[24:39], v[80:83], v[112:115], v[24:39]
v_mfma_f32_32x32x16_bf16 v[24:39], v[84:87], v[116:119], v[24:39]
v_mfma_f32_32x32x16_bf16 v[24:39], v[88:91], v[120:123], v[24:39]
v_mfma_f32_32x32x16_bf16 v[24:39], v[92:95], v[124:127], v[24:39]
s_nop 15
s_nop 3
s_and_b32 s28, s3, 1
s_lshl_b32 s28, s28, 6
v_lshl_add_u32 v18, v11, 4, v17
v_add_u32 v18, s28, v18
v_cvt_pk_bf16_f32 v40, v24, v25
v_cvt_pk_bf16_f32 v41, v26, v27
v_cvt_pk_bf16_f32 v42, v28, v29
v_cvt_pk_bf16_f32 v43, v30, v31
v_cvt_pk_bf16_f32 v44, v32, v33
v_cvt_pk_bf16_f32 v45, v34, v35
v_cvt_pk_bf16_f32 v46, v36, v37
v_cvt_pk_bf16_f32 v47, v38, v39
s_nop 1
v_permlane32_swap_b32 v40, v42
v_permlane32_swap_b32 v41, v43
v_permlane32_swap_b32 v44, v46
v_permlane32_swap_b32 v45, v47
v_cmp_gt_u32 vcc, 196, v16
s_and_b64 exec, exec, vcc
buffer_store_dwordx4 v[40:43], v18, s[16:19], 0 offen offset:0
buffer_store_dwordx4 v[44:47], v18, s[16:19], 0 offen offset:32
s_branch LB_end
LB_slow:
s_waitcnt vmcnt(0)
s_cmp_ge_u32 s3, 14
s_cbranch_scc1 LB_noW
s_and_b32 s28, s3, 1
s_lshl_b32 s28, s28, 6
v_and_b32 v3, 31, v2
v_lshlrev_b32 v3, 1, v3
v_lshrrev_b32 v4, 5, v2
v_lshl_add_u32 v3, v4, 10, v3
v_add_u32 v3, s28, v3
s_mov_b32 s61, 4096
s_mov_b32 s62, 8192
s_mov_b32 s63, 12288
buffer_load_ushort v64, v3, s[12:15], 0 offen offset:0
buffer_load_ushort v96, v3, s[12:15], 0 offen offset:128
buffer_load_ushort v65, v3, s[12:15], 0 offen offset:256
buffer_load_ushort v97, v3, s[12:15], 0 offen offset:384
buffer_load_ushort v66, v3, s[12:15], 0 offen offset:512
buffer_load_ushort v98, v3, s[12:15], 0 offen offset:640
buffer_load_ushort v67, v3, s[12:15], 0 offen offset:768
buffer_load_ushort v99, v3, s[12:15], 0 offen offset:896
buffer_load_ushort v68, v3, s[12:15], 0 offen offset:2048
buffer_load_ushort v100, v3, s[12:15], 0 offen offset:2176
buffer_load_ushort v69, v3, s[12:15], 0 offen offset:2304
buffer_load_ushort v101, v3, s[12:15], 0 offen offset:2432
buffer_load_ushort v70, v3, s[12:15], 0 offen offset:2560
buffer_load_ushort v102, v3, s[12:15], 0 offen offset:2688
buffer_load_ushort v71, v3, s[12:15], 0 offen offset:2816
buffer_load_ushort v103, v3, s[12:15], 0 offen offset:2944
buffer_load_ushort v72, v3, s[12:15], s61 offen offset:0
buffer_load_ushort v104, v3, s[12:15], s61 offen offset:128
buffer_load_ushort v73, v3, s[12:15], s61 offen offset:256
buffer_load_ushort v105, v3, s[12:15], s61 offen offset:384
buffer_load_ushort v74, v3, s[12:15], s61 offen offset:512
buffer_load_ushort v106, v3, s[12:15], s61 offen offset:640
buffer_load_ushort v75, v3, s[12:15], s61 offen offset:768
buffer_load_ushort v107, v3, s[12:15], s61 offen offset:896
buffer_load_ushort v76, v3, s[12:15], s61 offen offset:2048
buffer_load_ushort v108, v3, s[12:15], s61 offen offset:2176
buffer_load_ushort v77, v3, s[12:15], s61 offen offset:2304
buffer_load_ushort v109, v3, s[12:15], s61 offen offset:2432
buffer_load_ushort v78, v3, s[12:15], s61 offen offset:2560
buffer_load_ushort v110, v3, s[12:15], s61 offen offset:2688
buffer_load_ushort v79, v3, s[12:15], s61 offen offset:2816
buffer_load_ushort v111, v3, s[12:15], s61 offen offset:2944
buffer_load_ushort v80, v3, s[12:15], s62 offen offset:0
buffer_load_ushort v112, v3, s[12:15], s62 offen offset:128
buffer_load_ushort v81, v3, s[12:15], s62 offen offset:256
buffer_load_ushort v113, v3, s[12:15], s62 offen offset:384
buffer_load_ushort v82, v3, s[12:15], s62 offen offset:512
buffer_load_ushort v114, v3, s[12:15], s62 offen offset:640
buffer_load_ushort v83, v3, s[12:15], s62 offen offset:768
buffer_load_ushort v115, v3, s[12:15], s62 offen offset:896
buffer_load_ushort v84, v3, s[12:15], s62 offen offset:2048
buffer_load_ushort v116, v3, s[12:15], s62 offen offset:2176
buffer_load_ushort v85, v3, s[12:15], s62 offen offset:2304
buffer_load_ushort v117, v3, s[12:15], s62 offen offset:2432
buffer_load_ushort v86, v3, s[12:15], s62 offen offset:2560
buffer_load_ushort v118, v3, s[12:15], s62 offen offset:2688
buffer_load_ushort v87, v3, s[12:15], s62 offen offset:2816
buffer_load_ushort v119, v3, s[12:15], s62 offen offset:2944
buffer_load_ushort v88, v3, s[12:15], s63 offen offset:0
buffer_load_ushort v120, v3, s[12:15], s63 offen offset:128
buffer_load_ushort v89, v3, s[12:15], s63 offen offset:256
buffer_load_ushort v121, v3, s[12:15], s63 offen offset:384
buffer_load_ushort v90, v3, s[12:15], s63 offen offset:512
buffer_load_ushort v122, v3, s[12:15], s63 offen offset:640
buffer_load_ushort v91, v3, s[12:15], s63 offen offset:768
buffer_load_ushort v123, v3, s[12:15], s63 offen offset:896
buffer_load_ushort v92, v3, s[12:15], s63 offen offset:2048
buffer_load_ushort v124, v3, s[12:15], s63 offen offset:2176
buffer_load_ushort v93, v3, s[12:15], s63 offen offset:2304
buffer_load_ushort v125, v3, s[12:15], s63 offen offset:2432
buffer_load_ushort v94, v3, s[12:15], s63 offen offset:2560
buffer_load_ushort v126, v3, s[12:15], s63 offen offset:2688
buffer_load_ushort v95, v3, s[12:15], s63 offen offset:2816
buffer_load_ushort v127, v3, s[12:15], s63 offen offset:2944
LB_noW:
v_mov_b32 v4, 0
v_mov_b32 v5, 0
v_mov_b32 v6, 0
v_mov_b32 v7, 0
v_lshlrev_b32 v3, 4, v0
v_add_u32 v8, 0, v3
v_cmp_gt_u32 vcc, 50176, v8
s_and_saveexec_b64 s[28:29], vcc
v_add_u32 v8, 71696, v8
ds_write_b128 v8, v[4:7]
s_mov_b64 exec, s[28:29]
v_add_u32 v8, 16384, v3
v_cmp_gt_u32 vcc, 50176, v8
s_and_saveexec_b64 s[28:29], vcc
v_add_u32 v8, 71696, v8
ds_write_b128 v8, v[4:7]
s_mov_b64 exec, s[28:29]
v_add_u32 v8, 32768, v3
v_cmp_gt_u32 vcc, 50176, v8
s_and_saveexec_b64 s[28:29], vcc
v_add_u32 v8, 71696, v8
ds_write_b128 v8, v[4:7]
s_mov_b64 exec, s[28:29]
v_add_u32 v8, 49152, v3
v_cmp_gt_u32 vcc, 50176, v8
s_and_saveexec_b64 s[28:29], vcc
v_add_u32 v8, 71696, v8
ds_write_b128 v8, v[4:7]
s_mov_b64 exec, s[28:29]
s_cmp_lg_u32 s3, 0
s_cbranch_scc1 LB_notab
s_lshl_b32 s28, s2, 10
s_add_u32 s28, s28, 6406144
v_lshlrev_b32 v3, 4, v2
buffer_load_dwordx4 v[8:11], v3, s[20:23], s28 offen
s_waitcnt vmcnt(0)
v_lshrrev_b32 v12, 16, v8
v_and_b32 v8, 0xffff, v8
v_lshrrev_b32 v13, 16, v9
v_and_b32 v9, 0xffff, v9
v_lshrrev_b32 v14, 16, v10
v_and_b32 v10, 0xffff, v10
v_lshrrev_b32 v15, 16, v11
v_and_b32 v11, 0xffff, v11
v_add_u32 v16, v12, v13
v_add_u32 v17, v16, v14
v_add_u32 v18, v17, v15
s_nop 1
v_add_u32_dpp v18, v18, v18 row_shr:1 row_mask:0xf bank_mask:0xf bound_ctrl:0
s_nop 1
v_add_u32_dpp v18, v18, v18 row_shr:2 row_mask:0xf bank_mask:0xf bound_ctrl:0
s_nop 1
v_add_u32_dpp v18, v18, v18 row_shr:4 row_mask:0xf bank_mask:0xf bound_ctrl:0
s_nop 1
v_add_u32_dpp v18, v18, v18 row_shr:8 row_mask:0xf bank_mask:0xf bound_ctrl:0
s_nop 1
v_add_u32_dpp v18, v18, v18 row_bcast:15 row_mask:0xa bank_mask:0xf
s_nop 1
v_add_u32_dpp v18, v18, v18 row_bcast:31 row_mask:0xc bank_mask:0xf
s_nop 1
v_sub_u32 v20, v18, v17
v_sub_u32 v20, v20, v15
v_lshlrev_b32 v21, 6, v2
v_add_u32 v21, 67584, v21
v_lshlrev_b32 v19, 2, v2
s_mov_b32 s29, 25024
v_mov_b32 v24, v20
v_mov_b32 v25, v12
v_add_u32 v26, 0, v19
v_mul_lo_u32 v26, v26, s29
v_lshl_add_u32 v26, v8, 3, v26
v_mov_b32 v27, 0
ds_write_b128 v21, v[24:27] offset:0
v_add_u32 v24, v20, v12
v_mov_b32 v25, v13
v_add_u32 v26, 1, v19
v_mul_lo_u32 v26, v26, s29
v_lshl_add_u32 v26, v9, 3, v26
v_mov_b32 v27, 0
ds_write_b128 v21, v[24:27] offset:16
v_add_u32 v24, v20, v16
v_mov_b32 v25, v14
v_add_u32 v26, 2, v19
v_mul_lo_u32 v26, v26, s29
v_lshl_add_u32 v26, v10, 3, v26
v_mov_b32 v27, 0
ds_write_b128 v21, v[24:27] offset:32
v_add_u32 v24, v20, v17
v_mov_b32 v25, v15
v_add_u32 v26, 3, v19
v_mul_lo_u32 v26, v26, s29
v_lshl_add_u32 v26, v11, 3, v26
v_mov_b32 v27, 0
ds_write_b128 v21, v[24:27] offset:48
v_readlane_b32 s30, v18, 63
v_mov_b32 v3, 71680
s_nop 1
v_mov_b32 v4, s30
ds_write_b32 v3, v4
LB_notab:
s_waitcnt lgkmcnt(0)
s_barrier
v_mov_b32 v3, 71680
ds_read_b32 v4, v3
s_waitcnt lgkmcnt(0)
v_readfirstlane_b32 s31, v4
s_mov_b32 s32, 0
v_and_b32 v10, 31, v2
v_lshrrev_b32 v11, 5, v2
v_lshrrev_b32 v12, 4, v2
v_and_b32 v13, 15, v2
v_lshlrev_b32 v14, 3, v13
v_lshlrev_b32 v15, 2, v13
LB_batch:
s_cmp_ge_u32 s32, s31
s_cbranch_scc1 LB_mfma
s_add_u32 s33, s32, 4096
v_lshlrev_b32 v16, 2, v0
v_mov_b32 v17, 0
v_cmp_gt_u32 vcc, 256, v0
s_and_saveexec_b64 s[36:37], vcc
ds_write_b32 v16, v17 offset:0
s_mov_b64 exec, s[36:37]
s_lshl_b32 s34, s3, 4
v_add_u32 v16, s34, v11
v_lshlrev_b32 v16, 4, v16
v_add_u32 v16, 67584, v16
ds_read_b128 v[20:23], v16 offset:0
ds_read_b128 v[24:27], v16 offset:32
ds_read_b128 v[28:31], v16 offset:64
ds_read_b128 v[32:35], v16 offset:96
ds_read_b128 v[36:39], v16 offset:128
ds_read_b128 v[40:43], v16 offset:160
ds_read_b128 v[44:47], v16 offset:192
ds_read_b128 v[48:51], v16 offset:224
s_waitcnt lgkmcnt(0)
v_mov_b32 v23, v10
LB_seg0:
v_cmp_lt_u32 vcc, v23, v21
s_and_saveexec_b64 s[36:37], vcc
s_cbranch_execz LB_sege0
v_lshl_add_u32 v17, v23, 3, v22
buffer_load_dwordx2 v[18:19], v17, s[20:23], 0 offen
v_add_u32 v17, v20, v23
v_cmp_le_u32 vcc, s32, v17
v_cmp_gt_u32 s[38:39], s33, v17
s_and_b64 vcc, vcc, s[38:39]
s_and_b64 exec, exec, vcc
v_subrev_u32 v17, s32, v17
v_lshlrev_b32 v17, 3, v17
s_waitcnt vmcnt(0)
ds_write_b64 v17, v[18:19] offset:2048
s_mov_b64 exec, s[36:37]
v_add_u32 v23, 32, v23
s_branch LB_seg0
LB_sege0:
s_mov_b64 exec, s[36:37]
v_mov_b32 v27, v10
LB_seg1:
v_cmp_lt_u32 vcc, v27, v25
s_and_saveexec_b64 s[36:37], vcc
s_cbranch_execz LB_sege1
v_lshl_add_u32 v17, v27, 3, v26
buffer_load_dwordx2 v[18:19], v17, s[20:23], 0 offen
v_add_u32 v17, v24, v27
v_cmp_le_u32 vcc, s32, v17
v_cmp_gt_u32 s[38:39], s33, v17
s_and_b64 vcc, vcc, s[38:39]
s_and_b64 exec, exec, vcc
v_subrev_u32 v17, s32, v17
v_lshlrev_b32 v17, 3, v17
s_waitcnt vmcnt(0)
ds_write_b64 v17, v[18:19] offset:2048
s_mov_b64 exec, s[36:37]
v_add_u32 v27, 32, v27
s_branch LB_seg1
LB_sege1:
s_mov_b64 exec, s[36:37]
v_mov_b32 v31, v10
LB_seg2:
v_cmp_lt_u32 vcc, v31, v29
s_and_saveexec_b64 s[36:37], vcc
s_cbranch_execz LB_sege2
v_lshl_add_u32 v17, v31, 3, v30
buffer_load_dwordx2 v[18:19], v17, s[20:23], 0 offen
v_add_u32 v17, v28, v31
v_cmp_le_u32 vcc, s32, v17
v_cmp_gt_u32 s[38:39], s33, v17
s_and_b64 vcc, vcc, s[38:39]
s_and_b64 exec, exec, vcc
v_subrev_u32 v17, s32, v17
v_lshlrev_b32 v17, 3, v17
s_waitcnt vmcnt(0)
ds_write_b64 v17, v[18:19] offset:2048
s_mov_b64 exec, s[36:37]
v_add_u32 v31, 32, v31
s_branch LB_seg2
LB_sege2:
s_mov_b64 exec, s[36:37]
v_mov_b32 v35, v10
LB_seg3:
v_cmp_lt_u32 vcc, v35, v33
s_and_saveexec_b64 s[36:37], vcc
s_cbranch_execz LB_sege3
v_lshl_add_u32 v17, v35, 3, v34
buffer_load_dwordx2 v[18:19], v17, s[20:23], 0 offen
v_add_u32 v17, v32, v35
v_cmp_le_u32 vcc, s32, v17
v_cmp_gt_u32 s[38:39], s33, v17
s_and_b64 vcc, vcc, s[38:39]
s_and_b64 exec, exec, vcc
v_subrev_u32 v17, s32, v17
v_lshlrev_b32 v17, 3, v17
s_waitcnt vmcnt(0)
ds_write_b64 v17, v[18:19] offset:2048
s_mov_b64 exec, s[36:37]
v_add_u32 v35, 32, v35
s_branch LB_seg3
LB_sege3:
s_mov_b64 exec, s[36:37]
v_mov_b32 v39, v10
LB_seg4:
v_cmp_lt_u32 vcc, v39, v37
s_and_saveexec_b64 s[36:37], vcc
s_cbranch_execz LB_sege4
v_lshl_add_u32 v17, v39, 3, v38
buffer_load_dwordx2 v[18:19], v17, s[20:23], 0 offen
v_add_u32 v17, v36, v39
v_cmp_le_u32 vcc, s32, v17
v_cmp_gt_u32 s[38:39], s33, v17
s_and_b64 vcc, vcc, s[38:39]
s_and_b64 exec, exec, vcc
v_subrev_u32 v17, s32, v17
v_lshlrev_b32 v17, 3, v17
s_waitcnt vmcnt(0)
ds_write_b64 v17, v[18:19] offset:2048
s_mov_b64 exec, s[36:37]
v_add_u32 v39, 32, v39
s_branch LB_seg4
LB_sege4:
s_mov_b64 exec, s[36:37]
v_mov_b32 v43, v10
LB_seg5:
v_cmp_lt_u32 vcc, v43, v41
s_and_saveexec_b64 s[36:37], vcc
s_cbranch_execz LB_sege5
v_lshl_add_u32 v17, v43, 3, v42
buffer_load_dwordx2 v[18:19], v17, s[20:23], 0 offen
v_add_u32 v17, v40, v43
v_cmp_le_u32 vcc, s32, v17
v_cmp_gt_u32 s[38:39], s33, v17
s_and_b64 vcc, vcc, s[38:39]
s_and_b64 exec, exec, vcc
v_subrev_u32 v17, s32, v17
v_lshlrev_b32 v17, 3, v17
s_waitcnt vmcnt(0)
ds_write_b64 v17, v[18:19] offset:2048
s_mov_b64 exec, s[36:37]
v_add_u32 v43, 32, v43
s_branch LB_seg5
LB_sege5:
s_mov_b64 exec, s[36:37]
v_mov_b32 v47, v10
LB_seg6:
v_cmp_lt_u32 vcc, v47, v45
s_and_saveexec_b64 s[36:37], vcc
s_cbranch_execz LB_sege6
v_lshl_add_u32 v17, v47, 3, v46
buffer_load_dwordx2 v[18:19], v17, s[20:23], 0 offen
v_add_u32 v17, v44, v47
v_cmp_le_u32 vcc, s32, v17
v_cmp_gt_u32 s[38:39], s33, v17
s_and_b64 vcc, vcc, s[38:39]
s_and_b64 exec, exec, vcc
v_subrev_u32 v17, s32, v17
v_lshlrev_b32 v17, 3, v17
s_waitcnt vmcnt(0)
ds_write_b64 v17, v[18:19] offset:2048
s_mov_b64 exec, s[36:37]
v_add_u32 v47, 32, v47
s_branch LB_seg6
LB_sege6:
s_mov_b64 exec, s[36:37]
v_mov_b32 v51, v10
LB_seg7:
v_cmp_lt_u32 vcc, v51, v49
s_and_saveexec_b64 s[36:37], vcc
s_cbranch_execz LB_sege7
v_lshl_add_u32 v17, v51, 3, v50
buffer_load_dwordx2 v[18:19], v17, s[20:23], 0 offen
v_add_u32 v17, v48, v51
v_cmp_le_u32 vcc, s32, v17
v_cmp_gt_u32 s[38:39], s33, v17
s_and_b64 vcc, vcc, s[38:39]
s_and_b64 exec, exec, vcc
v_subrev_u32 v17, s32, v17
v_lshlrev_b32 v17, 3, v17
s_waitcnt vmcnt(0)
ds_write_b64 v17, v[18:19] offset:2048
s_mov_b64 exec, s[36:37]
v_add_u32 v51, 32, v51
s_branch LB_seg7
LB_sege7:
s_mov_b64 exec, s[36:37]
s_waitcnt lgkmcnt(0)
s_barrier
s_min_u32 s35, s33, s31
s_sub_u32 s35, s35, s32
v_mov_b32 v17, 1
v_add_u32 v16, 0, v0
v_cmp_gt_u32 s[46:47], s35, v16
s_mov_b64 exec, s[46:47]
v_lshlrev_b32 v16, 3, v16
ds_read_b64 v[20:21], v16 offset:2048
s_waitcnt lgkmcnt(0)
v_lshrrev_b32 v28, 16, v21
v_lshlrev_b32 v28, 2, v28
ds_add_rtn_u32 v32, v28, v17 offset:0
v_add_u32 v16, 1024, v0
v_cmp_gt_u32 s[48:49], s35, v16
s_mov_b64 exec, s[48:49]
v_lshlrev_b32 v16, 3, v16
ds_read_b64 v[22:23], v16 offset:2048
s_waitcnt lgkmcnt(0)
v_lshrrev_b32 v29, 16, v23
v_lshlrev_b32 v29, 2, v29
ds_add_rtn_u32 v33, v29, v17 offset:0
v_add_u32 v16, 2048, v0
v_cmp_gt_u32 s[50:51], s35, v16
s_mov_b64 exec, s[50:51]
v_lshlrev_b32 v16, 3, v16
ds_read_b64 v[24:25], v16 offset:2048
s_waitcnt lgkmcnt(0)
v_lshrrev_b32 v30, 16, v25
v_lshlrev_b32 v30, 2, v30
ds_add_rtn_u32 v34, v30, v17 offset:0
v_add_u32 v16, 3072, v0
v_cmp_gt_u32 s[52:53], s35, v16
s_mov_b64 exec, s[52:53]
v_lshlrev_b32 v16, 3, v16
ds_read_b64 v[26:27], v16 offset:2048
s_waitcnt lgkmcnt(0)
v_lshrrev_b32 v31, 16, v27
v_lshlrev_b32 v31, 2, v31
ds_add_rtn_u32 v35, v31, v17 offset:0
s_mov_b64 exec, -1
s_waitcnt lgkmcnt(0)
s_barrier
s_cmp_lg_u32 s3, 0
s_cbranch_scc1 LB_noscan
v_lshlrev_b32 v36, 4, v2
ds_read_b128 v[40:43], v36 offset:0
s_waitcnt lgkmcnt(0)
v_add_u32 v44, v40, v41
v_add_u32 v45, v44, v42
v_add_u32 v46, v45, v43
s_nop 1
v_add_u32_dpp v46, v46, v46 row_shr:1 row_mask:0xf bank_mask:0xf bound_ctrl:0
s_nop 1
v_add_u32_dpp v46, v46, v46 row_shr:2 row_mask:0xf bank_mask:0xf bound_ctrl:0
s_nop 1
v_add_u32_dpp v46, v46, v46 row_shr:4 row_mask:0xf bank_mask:0xf bound_ctrl:0
s_nop 1
v_add_u32_dpp v46, v46, v46 row_shr:8 row_mask:0xf bank_mask:0xf bound_ctrl:0
s_nop 1
v_add_u32_dpp v46, v46, v46 row_bcast:15 row_mask:0xa bank_mask:0xf
s_nop 1
v_add_u32_dpp v46, v46, v46 row_bcast:31 row_mask:0xc bank_mask:0xf
s_nop 1
v_sub_u32 v48, v46, v45
v_sub_u32 v48, v48, v43
v_add_u32 v49, v48, v40
v_add_u32 v50, v48, v44
v_add_u32 v51, v48, v45
ds_write_b128 v36, v[48:51] offset:1024
LB_noscan:
s_waitcnt lgkmcnt(0)
s_barrier
s_mov_b64 exec, s[46:47]
ds_read_b32 v16, v28 offset:1024
s_waitcnt lgkmcnt(0)
v_add_u32 v16, v16, v32
v_lshlrev_b32 v16, 3, v16
ds_write_b64 v16, v[20:21] offset:34816
s_mov_b64 exec, s[48:49]
ds_read_b32 v16, v29 offset:1024
s_waitcnt lgkmcnt(0)
v_add_u32 v16, v16, v33
v_lshlrev_b32 v16, 3, v16
ds_write_b64 v16, v[22:23] offset:34816
s_mov_b64 exec, s[50:51]
ds_read_b32 v16, v30 offset:1024
s_waitcnt lgkmcnt(0)
v_add_u32 v16, v16, v34
v_lshlrev_b32 v16, 3, v16
ds_write_b64 v16, v[24:25] offset:34816
s_mov_b64 exec, s[52:53]
ds_read_b32 v16, v31 offset:1024
s_waitcnt lgkmcnt(0)
v_add_u32 v16, v16, v35
v_lshlrev_b32 v16, 3, v16
ds_write_b64 v16, v[26:27] offset:34816
s_mov_b64 exec, -1
s_waitcnt lgkmcnt(0)
s_barrier
v_and_b32 v60, 1, v12
s_mov_b32 s44, s3
LB_g:
s_cmp_ge_u32 s44, 98
s_cbranch_scc1 LB_gend
s_lshl_b32 s45, s44, 1
v_add_u32 v16, s45, v11
v_lshlrev_b32 v17, 2, v16
ds_read_b32 v18, v17 offset:1024
ds_read_b32 v19, v17 offset:0
v_mov_b32 v52, 0
v_mov_b32 v53, 0
v_mov_b32 v54, 0
v_mov_b32 v55, 0
v_mov_b32 v61, v60
s_waitcnt lgkmcnt(0)
LB_p:
v_cmp_lt_u32 vcc, v61, v19
s_cbranch_vccz LB_pend
v_add_u32 v17, v18, v61
v_lshlrev_b32 v17, 3, v17
v_add_u32 v62, 0, v61
v_cmp_lt_u32 s[46:47], v62, v19
s_mov_b64 exec, s[46:47]
ds_read_b64 v[20:21], v17 offset:34816
v_add_u32 v62, 2, v61
v_cmp_lt_u32 s[48:49], v62, v19
s_mov_b64 exec, s[48:49]
ds_read_b64 v[22:23], v17 offset:34832
v_add_u32 v62, 4, v61
v_cmp_lt_u32 s[50:51], v62, v19
s_mov_b64 exec, s[50:51]
ds_read_b64 v[24:25], v17 offset:34848
v_add_u32 v62, 6, v61
v_cmp_lt_u32 s[52:53], v62, v19
s_mov_b64 exec, s[52:53]
ds_read_b64 v[26:27], v17 offset:34864
v_add_u32 v62, 8, v61
v_cmp_lt_u32 s[54:55], v62, v19
s_mov_b64 exec, s[54:55]
ds_read_b64 v[28:29], v17 offset:34880
v_add_u32 v62, 10, v61
v_cmp_lt_u32 s[56:57], v62, v19
s_mov_b64 exec, s[56:57]
ds_read_b64 v[30:31], v17 offset:34896
v_add_u32 v62, 12, v61
v_cmp_lt_u32 s[58:59], v62, v19
s_mov_b64 exec, s[58:59]
ds_read_b64 v[32:33], v17 offset:34912
v_add_u32 v62, 14, v61
v_cmp_lt_u32 s[60:61], v62, v19
s_mov_b64 exec, s[60:61]
ds_read_b64 v[34:35], v17 offset:34928
s_mov_b64 exec, -1
s_waitcnt lgkmcnt(0)
v_lshl_add_u32 v62, v20, 7, v14
s_mov_b64 exec, s[46:47]
buffer_load_dwordx2 v[36:37], v62, s[8:11], 0 offen
s_mov_b64 exec, -1
v_lshl_add_u32 v62, v22, 7, v14
s_mov_b64 exec, s[48:49]
buffer_load_dwordx2 v[38:39], v62, s[8:11], 0 offen
s_mov_b64 exec, -1
v_lshl_add_u32 v62, v24, 7, v14
s_mov_b64 exec, s[50:51]
buffer_load_dwordx2 v[40:41], v62, s[8:11], 0 offen
s_mov_b64 exec, -1
v_lshl_add_u32 v62, v26, 7, v14
s_mov_b64 exec, s[52:53]
buffer_load_dwordx2 v[42:43], v62, s[8:11], 0 offen
s_mov_b64 exec, -1
v_lshl_add_u32 v62, v28, 7, v14
s_mov_b64 exec, s[54:55]
buffer_load_dwordx2 v[44:45], v62, s[8:11], 0 offen
s_mov_b64 exec, -1
v_lshl_add_u32 v62, v30, 7, v14
s_mov_b64 exec, s[56:57]
buffer_load_dwordx2 v[46:47], v62, s[8:11], 0 offen
s_mov_b64 exec, -1
v_lshl_add_u32 v62, v32, 7, v14
s_mov_b64 exec, s[58:59]
buffer_load_dwordx2 v[48:49], v62, s[8:11], 0 offen
s_mov_b64 exec, -1
v_lshl_add_u32 v62, v34, 7, v14
s_mov_b64 exec, s[60:61]
buffer_load_dwordx2 v[50:51], v62, s[8:11], 0 offen
s_mov_b64 exec, -1
v_lshlrev_b32 v62, 16, v21
s_waitcnt vmcnt(7)
s_mov_b64 exec, s[46:47]
v_lshlrev_b32 v56, 16, v36
v_and_b32 v57, 0xffff0000, v36
v_lshlrev_b32 v58, 16, v37
v_and_b32 v59, 0xffff0000, v37
v_fmac_f32 v52, v62, v56
v_fmac_f32 v53, v62, v57
v_fmac_f32 v54, v62, v58
v_fmac_f32 v55, v62, v59
s_mov_b64 exec, -1
v_lshlrev_b32 v62, 16, v23
s_waitcnt vmcnt(6)
s_mov_b64 exec, s[48:49]
v_lshlrev_b32 v56, 16, v38
v_and_b32 v57, 0xffff0000, v38
v_lshlrev_b32 v58, 16, v39
v_and_b32 v59, 0xffff0000, v39
v_fmac_f32 v52, v62, v56
v_fmac_f32 v53, v62, v57
v_fmac_f32 v54, v62, v58
v_fmac_f32 v55, v62, v59
s_mov_b64 exec, -1
v_lshlrev_b32 v62, 16, v25
s_waitcnt vmcnt(5)
s_mov_b64 exec, s[50:51]
v_lshlrev_b32 v56, 16, v40
v_and_b32 v57, 0xffff0000, v40
v_lshlrev_b32 v58, 16, v41
v_and_b32 v59, 0xffff0000, v41
v_fmac_f32 v52, v62, v56
v_fmac_f32 v53, v62, v57
v_fmac_f32 v54, v62, v58
v_fmac_f32 v55, v62, v59
s_mov_b64 exec, -1
v_lshlrev_b32 v62, 16, v27
s_waitcnt vmcnt(4)
s_mov_b64 exec, s[52:53]
v_lshlrev_b32 v56, 16, v42
v_and_b32 v57, 0xffff0000, v42
v_lshlrev_b32 v58, 16, v43
v_and_b32 v59, 0xffff0000, v43
v_fmac_f32 v52, v62, v56
v_fmac_f32 v53, v62, v57
v_fmac_f32 v54, v62, v58
v_fmac_f32 v55, v62, v59
s_mov_b64 exec, -1
v_lshlrev_b32 v62, 16, v29
s_waitcnt vmcnt(3)
s_mov_b64 exec, s[54:55]
v_lshlrev_b32 v56, 16, v44
v_and_b32 v57, 0xffff0000, v44
v_lshlrev_b32 v58, 16, v45
v_and_b32 v59, 0xffff0000, v45
v_fmac_f32 v52, v62, v56
v_fmac_f32 v53, v62, v57
v_fmac_f32 v54, v62, v58
v_fmac_f32 v55, v62, v59
s_mov_b64 exec, -1
v_lshlrev_b32 v62, 16, v31
s_waitcnt vmcnt(2)
s_mov_b64 exec, s[56:57]
v_lshlrev_b32 v56, 16, v46
v_and_b32 v57, 0xffff0000, v46
v_lshlrev_b32 v58, 16, v47
v_and_b32 v59, 0xffff0000, v47
v_fmac_f32 v52, v62, v56
v_fmac_f32 v53, v62, v57
v_fmac_f32 v54, v62, v58
v_fmac_f32 v55, v62, v59
s_mov_b64 exec, -1
v_lshlrev_b32 v62, 16, v33
s_waitcnt vmcnt(1)
s_mov_b64 exec, s[58:59]
v_lshlrev_b32 v56, 16, v48
v_and_b32 v57, 0xffff0000, v48
v_lshlrev_b32 v58, 16, v49
v_and_b32 v59, 0xffff0000, v49
v_fmac_f32 v52, v62, v56
v_fmac_f32 v53, v62, v57
v_fmac_f32 v54, v62, v58
v_fmac_f32 v55, v62, v59
s_mov_b64 exec, -1
v_lshlrev_b32 v62, 16, v35
s_waitcnt vmcnt(0)
s_mov_b64 exec, s[60:61]
v_lshlrev_b32 v56, 16, v50
v_and_b32 v57, 0xffff0000, v50
v_lshlrev_b32 v58, 16, v51
v_and_b32 v59, 0xffff0000, v51
v_fmac_f32 v52, v62, v56
v_fmac_f32 v53, v62, v57
v_fmac_f32 v54, v62, v58
v_fmac_f32 v55, v62, v59
s_mov_b64 exec, -1
v_add_u32 v61, 16, v61
s_branch LB_p
LB_pend:
v_lshlrev_b32 v17, 8, v16
v_lshl_add_u32 v17, v13, 4, v17
v_add_u32 v17, 71696, v17
ds_read_b128 v[20:23], v17
v_mov_b32 v56, v52
v_mov_b32 v57, v53
v_mov_b32 v58, v54
v_mov_b32 v59, v55
s_nop 1
v_permlane16_swap_b32 v52, v56
v_permlane16_swap_b32 v53, v57
v_permlane16_swap_b32 v54, v58
v_permlane16_swap_b32 v55, v59
s_waitcnt lgkmcnt(0)
v_add_f32 v52, v52, v56
v_add_f32 v20, v20, v52
v_add_f32 v53, v53, v57
v_add_f32 v21, v21, v53
v_add_f32 v54, v54, v58
v_add_f32 v22, v22, v54
v_add_f32 v55, v55, v59
v_add_f32 v23, v23, v55
v_cmp_eq_u32 vcc, 0, v60
s_and_saveexec_b64 s[36:37], vcc
ds_write_b128 v17, v[20:23]
s_mov_b64 exec, s[36:37]
s_add_u32 s44, s44, 16
s_branch LB_g
LB_gend:
s_waitcnt lgkmcnt(0)
s_barrier
s_mov_b32 s32, s33
s_branch LB_batch
LB_mfma:
s_cmp_ge_u32 s3, 14
s_cbranch_scc1 LB_end
s_lshr_b32 s28, s3, 1
s_lshl_b32 s28, s28, 5
v_add_u32 v16, s28, v10
s_mul_i32 s29, s2, 196
v_add_u32 v17, s29, v16
v_lshlrev_b32 v17, 7, v17
v_lshl_add_u32 v18, v11, 4, v17
s_waitcnt vmcnt(0)
v_lshl_or_b32 v64, v96, 16, v64
v_lshl_or_b32 v65, v97, 16, v65
v_lshl_or_b32 v66, v98, 16, v66
v_lshl_or_b32 v67, v99, 16, v67
v_lshl_or_b32 v68, v100, 16, v68
v_lshl_or_b32 v69, v101, 16, v69
v_lshl_or_b32 v70, v102, 16, v70
v_lshl_or_b32 v71, v103, 16, v71
v_lshl_or_b32 v72, v104, 16, v72
v_lshl_or_b32 v73, v105, 16, v73
v_lshl_or_b32 v74, v106, 16, v74
v_lshl_or_b32 v75, v107, 16, v75
v_lshl_or_b32 v76, v108, 16, v76
v_lshl_or_b32 v77, v109, 16, v77
v_lshl_or_b32 v78, v110, 16, v78
v_lshl_or_b32 v79, v111, 16, v79
v_lshl_or_b32 v80, v112, 16, v80
v_lshl_or_b32 v81, v113, 16, v81
v_lshl_or_b32 v82, v114, 16, v82
v_lshl_or_b32 v83, v115, 16, v83
v_lshl_or_b32 v84, v116, 16, v84
v_lshl_or_b32 v85, v117, 16, v85
v_lshl_or_b32 v86, v118, 16, v86
v_lshl_or_b32 v87, v119, 16, v87
v_lshl_or_b32 v88, v120, 16, v88
v_lshl_or_b32 v89, v121, 16, v89
v_lshl_or_b32 v90, v122, 16, v90
v_lshl_or_b32 v91, v123, 16, v91
v_lshl_or_b32 v92, v124, 16, v92
v_lshl_or_b32 v93, v125, 16, v93
v_lshl_or_b32 v94, v126, 16, v94
v_lshl_or_b32 v95, v127, 16, v95
buffer_load_dwordx4 v[96:99], v18, s[8:11], 0 offen offset:0
buffer_load_dwordx4 v[100:103], v18, s[8:11], 0 offen offset:32
buffer_load_dwordx4 v[104:107], v18, s[8:11], 0 offen offset:64
buffer_load_dwordx4 v[108:111], v18, s[8:11], 0 offen offset:96
v_min_u32 v19, 195, v16
v_lshlrev_b32 v19, 8, v19
v_lshl_add_u32 v19, v11, 5, v19
v_add_u32 v19, 71696, v19
ds_read_b128 v[24:27], v19 offset:0
ds_read_b128 v[28:31], v19 offset:16
ds_read_b128 v[32:35], v19 offset:64
ds_read_b128 v[36:39], v19 offset:80
ds_read_b128 v[40:43], v19 offset:128
ds_read_b128 v[44:47], v19 offset:144
ds_read_b128 v[48:51], v19 offset:192
ds_read_b128 v[52:55], v19 offset:208
s_waitcnt lgkmcnt(0)
v_cvt_pk_bf16_f32 v112, v24, v25
v_cvt_pk_bf16_f32 v113, v26, v27
v_cvt_pk_bf16_f32 v114, v28, v29
v_cvt_pk_bf16_f32 v115, v30, v31
v_cvt_pk_bf16_f32 v116, v32, v33
v_cvt_pk_bf16_f32 v117, v34, v35
v_cvt_pk_bf16_f32 v118, v36, v37
v_cvt_pk_bf16_f32 v119, v38, v39
v_cvt_pk_bf16_f32 v120, v40, v41
v_cvt_pk_bf16_f32 v121, v42, v43
v_cvt_pk_bf16_f32 v122, v44, v45
v_cvt_pk_bf16_f32 v123, v46, v47
v_cvt_pk_bf16_f32 v124, v48, v49
v_cvt_pk_bf16_f32 v125, v50, v51
v_cvt_pk_bf16_f32 v126, v52, v53
v_cvt_pk_bf16_f32 v127, v54, v55
v_mov_b32 v24, 0
v_mov_b32 v25, 0
v_mov_b32 v26, 0
v_mov_b32 v27, 0
v_mov_b32 v28, 0
v_mov_b32 v29, 0
v_mov_b32 v30, 0
v_mov_b32 v31, 0
v_mov_b32 v32, 0
v_mov_b32 v33, 0
v_mov_b32 v34, 0
v_mov_b32 v35, 0
v_mov_b32 v36, 0
v_mov_b32 v37, 0
v_mov_b32 v38, 0
v_mov_b32 v39, 0
s_waitcnt vmcnt(0)
s_nop 1
v_mfma_f32_32x32x16_bf16 v[24:39], v[64:67], v[96:99], v[24:39]
v_mfma_f32_32x32x16_bf16 v[24:39], v[68:71], v[100:103], v[24:39]
v_mfma_f32_32x32x16_bf16 v[24:39], v[72:75], v[104:107], v[24:39]
v_mfma_f32_32x32x16_bf16 v[24:39], v[76:79], v[108:111], v[24:39]
v_mfma_f32_32x32x16_bf16 v[24:39], v[80:83], v[112:115], v[24:39]
v_mfma_f32_32x32x16_bf16 v[24:39], v[84:87], v[116:119], v[24:39]
v_mfma_f32_32x32x16_bf16 v[24:39], v[88:91], v[120:123], v[24:39]
v_mfma_f32_32x32x16_bf16 v[24:39], v[92:95], v[124:127], v[24:39]
s_nop 15
s_nop 3
v_cmp_gt_u32 vcc, 196, v16
s_and_b64 exec, exec, vcc
s_and_b32 s28, s3, 1
s_lshl_b32 s28, s28, 6
v_lshl_add_u32 v18, v11, 3, v17
v_add_u32 v18, s28, v18
v_cvt_pk_bf16_f32 v40, v24, v25
v_cvt_pk_bf16_f32 v41, v26, v27
buffer_store_dwordx2 v[40:41], v18, s[16:19], 0 offen offset:0
v_cvt_pk_bf16_f32 v42, v28, v29
v_cvt_pk_bf16_f32 v43, v30, v31
buffer_store_dwordx2 v[42:43], v18, s[16:19], 0 offen offset:16
v_cvt_pk_bf16_f32 v44, v32, v33
v_cvt_pk_bf16_f32 v45, v34, v35
buffer_store_dwordx2 v[44:45], v18, s[16:19], 0 offen offset:32
v_cvt_pk_bf16_f32 v46, v36, v37
v_cvt_pk_bf16_f32 v47, v38, v39
buffer_store_dwordx2 v[46:47], v18, s[16:19], 0 offen offset:48
LB_end:
s_endpgm
.section .rodata,"a"
.p2align 6
.amdhsa_kernel cheb_a_kernel
  .amdhsa_next_free_vgpr 80
  .amdhsa_next_free_sgpr 100
  .amdhsa_accum_offset 80
  .amdhsa_group_segment_fixed_size 0
  .amdhsa_kernarg_size 64
  .amdhsa_user_sgpr_count 2
  .amdhsa_user_sgpr_kernarg_segment_ptr 1
  .amdhsa_system_sgpr_workgroup_id_x 1
.end_amdhsa_kernel
.p2align 6
.amdhsa_kernel cheb_b_kernel
  .amdhsa_next_free_vgpr 128
  .amdhsa_next_free_sgpr 100
  .amdhsa_accum_offset 128
  .amdhsa_group_segment_fixed_size 0
  .amdhsa_kernarg_size 64
  .amdhsa_user_sgpr_count 2
  .amdhsa_user_sgpr_kernarg_segment_ptr 1
  .amdhsa_system_sgpr_workgroup_id_x 1
.end_amdhsa_kernel
```
